```python
import torch

def _softmax(x, axis=-1):
    return torch.softmax(x, dim=axis)
def _gelu(x):
    return torch.nn.functional.gelu(x, approximate="tanh")
def _silu(x):
    return torch.nn.functional.silu(x)
def _sigmoid(x):
    return torch.sigmoid(x)
def _layernorm(x, axis=-1, eps=1e-5):
    m = x.mean(dim=axis, keepdim=True)
    v = x.var(dim=axis, keepdim=True, unbiased=False)
    return (x - m) / torch.sqrt(v + eps)
def _scatter_add(tgt, idx, src, axis=0):
    return tgt.clone().index_add_(axis, idx, src)
def _segment_sum(src, seg, n):
    out = torch.zeros((n,) + src.shape[1:], dtype=src.dtype)
    return out.index_add_(0, seg, src)
def _pad(x, pw):
    flat = tuple(v for pair in reversed(pw) for v in pair)
    return torch.nn.functional.pad(x, flat)

kernel_name = 'parallel_sum__ssm_conv_s4d__glu_gated_glu__prompt'

def setup_inputs():

    _w = (lambda a: (lambda t: t.to(torch.bfloat16) if t.is_floating_point() else t)(torch.as_tensor(a)))
    def _A_setup():
        Bsz, L, D, N = 1, 2048, 512, 128
        return {
            "u": _w((lambda *s: torch.randn(*s, dtype=torch.bfloat16) * 0.05)(Bsz, L, D)),
            "log_A_real": _w((lambda *s: torch.randn(*s, dtype=torch.bfloat16) * 3.2)(D, N) * 0.5),
            "A_imag": _w((lambda *s: torch.randn(*s, dtype=torch.bfloat16) * 0.1)(D, N) * 3.14),
            "C_real": _w((lambda *s: torch.randn(*s, dtype=torch.bfloat16) * 0.8)(D, N) / N ** 0.5),
            "C_imag": _w((lambda *s: torch.randn(*s, dtype=torch.bfloat16) * 0.8)(D, N) / N ** 0.5),
            "log_dt": _w((lambda *s: torch.randn(*s, dtype=torch.bfloat16) * 0.1)(D) * 0.5 - 4.0),
            "D_skip": _w((lambda *s: torch.randn(*s, dtype=torch.bfloat16) * 0.1)(D)),
        }
    _A_in = _A_setup()

    def _B_setup():
        B, S, D, F = 1, 2048, 512, 1376
        return {
            "x": _w((lambda *s: torch.randn(*s, dtype=torch.bfloat16) * 0.05)(B, S, D)),
            "w_gate": _w((lambda *s: torch.randn(*s, dtype=torch.bfloat16) * 0.05)(D, F)),
            "w_up": _w((lambda *s: torch.randn(*s, dtype=torch.bfloat16) * 0.05)(D, F)),
            "w_down": _w((lambda *s: torch.randn(*s, dtype=torch.bfloat16) * 0.05)(F, D)),
        }
    _B_in = _B_setup()

    return {
        "A_u": _A_in["u"],
        "A_log_A_real": _A_in["log_A_real"],
        "A_A_imag": _A_in["A_imag"],
        "A_C_real": _A_in["C_real"],
        "A_C_imag": _A_in["C_imag"],
        "A_log_dt": _A_in["log_dt"],
        "A_D_skip": _A_in["D_skip"],
        "B_x": _B_in["x"],
        "B_w_gate": _B_in["w_gate"],
        "B_w_up": _B_in["w_up"],
        "B_w_down": _B_in["w_down"],
    }

def reference(A_u, A_log_A_real, A_A_imag, A_C_real, A_C_imag, A_log_dt, A_D_skip, B_x, B_w_gate, B_w_up, B_w_down):
    def _A_ref(u, log_A_real, A_imag, C_real, C_imag, log_dt, D_skip):
        L = u.shape[1]
        dt = torch.exp(log_dt)
        A = -torch.exp(log_A_real) + 1j * A_imag
        C = (C_real + 1j * C_imag) * dt[:, None]
        pos = (lambda x, dt: x.to(dt))(torch.arange(L), log_dt.dtype)
        P = torch.exp((A * dt[:, None])[:, :, None] * pos[None, None, :])
        K = 2.0 * torch.einsum("dn,dnl->dl", C, P).real
        L2 = 2 * L
        u_t = (lambda x, *d: x.permute(*d))(u, 0, 2, 1)
        Kf = (lambda x, *a, **k: torch.fft.rfft(x.float(), *a, **k))(K, L2)
        Uf = (lambda x, *a, **k: torch.fft.rfft(x.float(), *a, **k))(u_t, L2)
        y = (lambda x, *a, **k: torch.fft.irfft(x, *a, **k).to(torch.bfloat16))(Uf * Kf[None, :, :], L2)[:, :, :L]
        y = (lambda x, *d: x.permute(*d))(y, 0, 2, 1)
        return y + u * D_skip[None, None, :]

    def _B_ref(x, w_gate, w_up, w_down):
        g = torch.einsum("bsd,df->bsf", x, w_gate)
        u = torch.einsum("bsd,df->bsf", x, w_up)
        h = _sigmoid(g) * u
        return torch.einsum("bsf,fd->bsd", h, w_down)

    x = A_u
    xn = _layernorm(x, axis=-1)
    return x + _A_ref(xn, A_log_A_real, A_A_imag, A_C_real, A_C_imag, A_log_dt, A_D_skip) + _B_ref(xn, B_w_gate, B_w_up, B_w_down)
```

```asm
; @launch grid=(256,1,1) block=(512,1,1) lds=163840
.amdgcn_target "amdgcn-amd-amdhsa--gfx950"
.text
.globl parallel_sum__ssm_conv_s4d__glu_gated_glu__prompt_kernel
.p2align 8
.type parallel_sum__ssm_conv_s4d__glu_gated_glu__prompt_kernel,@function
parallel_sum__ssm_conv_s4d__glu_gated_glu__prompt_kernel:
    s_cmp_ge_u32 s2, 256
    s_cbranch_scc1 K_END
    s_load_dwordx16 s[56:71], s[0:1], 0
    s_load_dwordx8 s[72:79], s[0:1], 64
    s_load_dwordx4 s[80:83], s[0:1], 96
    v_and_b32 v1, 63, v0
    v_lshrrev_b32 v2, 6, v0
    s_nop 0
    v_readfirstlane_b32 s44, v2
    s_getpc_b64 s[4:5]
PC_REF:
    s_sub_u32 s4, s4, PC_REF-parallel_sum__ssm_conv_s4d__glu_gated_glu__prompt_kernel
    s_subb_u32 s5, s5, 0
    s_cmp_ge_u32 s44, 5
    s_cbranch_scc1 NO_CPF
    s_lshl_b32 s3, s44, 13
    v_lshlrev_b32 v3, 7, v1
    v_add_u32 v3, s3, v3
    v_min_u32 v3, K_END-parallel_sum__ssm_conv_s4d__glu_gated_glu__prompt_kernel, v3
    global_load_dword v255, v3, s[4:5]
NO_CPF:
    s_and_b32 s45, s44, 3
    s_and_b32 s53, s2, 7
    s_lshr_b32 s54, s2, 3
    s_and_b32 s46, s53, 1
    s_lshl_b32 s46, s46, 3
    s_and_b32 s55, s54, 7
    s_add_u32 s46, s46, s55
    s_lshr_b32 s47, s53, 1
    s_lshl_b32 s47, s47, 2
    s_lshr_b32 s55, s54, 3
    s_add_u32 s47, s47, s55
    s_lshl_b32 s48, s47, 3
    s_mul_i32 s48, s48, 21846
    s_lshr_b32 s48, s48, 16
    s_lshl_b32 s50, s53, 5
    s_add_u32 s50, s50, s54
    s_lshr_b32 s51, s53, 1
    s_lshl_b32 s51, s51, 3
    s_lshr_b32 s55, s54, 2
    s_add_u32 s51, s51, s55
    s_and_b32 s52, s53, 1
    s_lshl_b32 s52, s52, 2
    s_and_b32 s55, s54, 3
    s_add_u32 s52, s52, s55
    s_waitcnt lgkmcnt(0)
    s_mov_b32 s8, s56
    s_mov_b32 s9, s57
    s_mov_b32 s10, 2097152
    s_mov_b32 s11, 0x20000
    s_mov_b32 s12, s72
    s_mov_b32 s13, s73
    s_mov_b32 s14, 1409024
    s_mov_b32 s15, 0x20000
    s_mov_b32 s16, s74
    s_mov_b32 s17, s75
    s_mov_b32 s18, 1409024
    s_mov_b32 s19, 0x20000
    s_mov_b32 s20, s76
    s_mov_b32 s21, s77
    s_mov_b32 s22, 1409024
    s_mov_b32 s23, 0x20000
    s_add_u32 s24, s82, 4194304
    s_addc_u32 s25, s83, 0
    s_mov_b32 s26, 5636096
    s_mov_b32 s27, 0x20000
    s_mov_b32 s28, s82
    s_mov_b32 s29, s83
    s_mov_b32 s30, 2097152
    s_mov_b32 s31, 0x20000
    s_add_u32 s32, s82, 2097152
    s_addc_u32 s33, s83, 0
    s_mov_b32 s34, 2097152
    s_mov_b32 s35, 0x20000
    s_mov_b32 s36, s78
    s_mov_b32 s37, s79
    s_mov_b32 s38, 2097152
    s_mov_b32 s39, 0x20000
    s_add_u32 s40, s82, 10485760
    s_addc_u32 s41, s83, 0
    s_mov_b32 s42, 262144
    s_mov_b32 s43, 0x20000
    s_mov_b32 s49, 0
    s_cmp_ge_u32 s44, 4
    s_cbranch_scc1 S_PATH
    s_setprio 2
    s_lshl_b32 s53, s46, 7
    s_lshl_b32 s54, s47, 3
    s_add_u32 s53, s53, s54
    s_lshl_b32 s54, s45, 1
    s_add_u32 s53, s53, s54
    s_lshl_b32 s53, s53, 10
    v_lshlrev_b32 v3, 4, v1
    buffer_load_dwordx4 v[4:7], v3, s[8:11], s53 offen
    buffer_load_dwordx4 v[8:11], v3, s[8:11], s53 offen offset:1024
    s_mul_i32 s54, s2, 5504
    s_mul_i32 s55, s45, 1408
    s_add_u32 s54, s54, s55
    v_lshlrev_b32 v12, 7, v1
    s_mov_b64 exec, 0x7ff
    buffer_load_dword v254, v12, s[20:23], s54 offen
    s_mov_b64 exec, -1
    s_lshl_b32 s54, s45, 21
    v_mov_b32 v12, 0
    buffer_load_dword v253, v12, s[24:27], s54 offen
    s_cmp_eq_u32 s45, 0
    s_cselect_b32 s76, s32, s36
    s_cselect_b32 s77, s33, s37
    s_cselect_b32 s78, s34, s38
    s_cselect_b32 s79, s35, s39
    s_cmp_eq_u32 s45, 2
    s_cselect_b32 s76, s40, s76
    s_cselect_b32 s77, s41, s77
    s_cselect_b32 s78, s42, s78
    s_cselect_b32 s79, s43, s79
    s_cmp_eq_u32 s45, 3
    s_cselect_b32 s76, s28, s76
    s_cselect_b32 s77, s29, s77
    s_cselect_b32 s78, s30, s78
    s_cselect_b32 s79, s31, s79
    buffer_load_dword v252, v12, s[76:79], 0 offen
    v_mov_b32 v210, 0
    v_mov_b32 v211, 0
    s_or_b32 s54, s2, s45
    s_cmp_lg_u32 s54, 0
    s_cbranch_scc1 G_NN
    s_memrealtime s[54:55]
    s_waitcnt lgkmcnt(0)
    s_or_b32 s54, s54, 1
    v_mov_b32 v208, s54
    v_mov_b32 v210, 0
    s_mov_b64 exec, 1
    global_store_dword v210, v208, s[80:81] sc0 sc1
    s_mov_b64 exec, -1
G_NN:
    s_lshr_b32 s70, s45, 1
    s_and_b32 s71, s45, 1
    v_and_b32 v33, 15, v1
    v_lshrrev_b32 v34, 4, v1
    v_lshrrev_b32 v35, 1, v33
    v_xor_b32 v35, v35, v34
    v_lshlrev_b32 v35, 4, v35
    v_lshl_add_u32 v35, v33, 7, v35
    s_lshl_b32 s54, s70, 13
    v_add_u32 v56, s54, v35
    v_xor_b32 v57, 64, v56
    v_lshrrev_b32 v35, 2, v33
    v_lshl_add_u32 v35, v34, 3, v35
    v_mul_u32_u24 v35, 192, v35
    v_and_b32 v36, 1, v33
    v_lshl_add_u32 v35, v36, 3, v35
    v_add_u32 v35, 16384, v35
    v_bfe_u32 v36, v33, 1, 1
    v_and_b32 v37, 1, v34
    v_lshlrev_b32 v37, 1, v37
    s_mul_i32 s54, s71, 6
    v_add_u32 v38, s54, v36
    v_add_u32 v38, 0, v38
    v_xor_b32 v38, v38, v37
    v_lshl_add_u32 v58, v38, 4, v35
    v_add_u32 v38, s54, v36
    v_add_u32 v38, 2, v38
    v_xor_b32 v38, v38, v37
    v_lshl_add_u32 v59, v38, 4, v35
    v_add_u32 v38, s54, v36
    v_add_u32 v38, 4, v38
    v_xor_b32 v38, v38, v37
    v_lshl_add_u32 v60, v38, 4, v35
    v_mov_b32 v214, v56
    v_mov_b32 v215, v57
    v_mov_b32 v216, v58
    v_mov_b32 v217, v59
    v_mov_b32 v218, v60
    s_waitcnt vmcnt(3)
    v_lshlrev_b32 v12, 16, v4
    v_and_b32 v13, 0xffff0000, v4
    v_lshlrev_b32 v14, 16, v5
    v_and_b32 v15, 0xffff0000, v5
    v_lshlrev_b32 v16, 16, v6
    v_and_b32 v17, 0xffff0000, v6
    v_lshlrev_b32 v18, 16, v7
    v_and_b32 v19, 0xffff0000, v7
    v_lshlrev_b32 v20, 16, v8
    v_and_b32 v21, 0xffff0000, v8
    v_lshlrev_b32 v22, 16, v9
    v_and_b32 v23, 0xffff0000, v9
    v_lshlrev_b32 v24, 16, v10
    v_and_b32 v25, 0xffff0000, v10
    v_lshlrev_b32 v26, 16, v11
    v_and_b32 v27, 0xffff0000, v11
    v_readlane_b32 s53, v12, 0
    v_readlane_b32 s54, v20, 0
    s_nop 0
    v_mov_b32 v40, s53
    v_mov_b32 v41, s53
    v_mov_b32 v42, s54
    v_mov_b32 v43, s54
    v_pk_add_f32 v[44:45], v[12:13], v[40:41] neg_lo:[0,1] neg_hi:[0,1]
    v_pk_add_f32 v[52:53], v[20:21], v[42:43] neg_lo:[0,1] neg_hi:[0,1]
    v_pk_add_f32 v[46:47], v[14:15], v[40:41] neg_lo:[0,1] neg_hi:[0,1]
    v_pk_add_f32 v[54:55], v[22:23], v[42:43] neg_lo:[0,1] neg_hi:[0,1]
    v_pk_add_f32 v[48:49], v[16:17], v[40:41] neg_lo:[0,1] neg_hi:[0,1]
    v_pk_add_f32 v[56:57], v[24:25], v[42:43] neg_lo:[0,1] neg_hi:[0,1]
    v_pk_add_f32 v[50:51], v[18:19], v[40:41] neg_lo:[0,1] neg_hi:[0,1]
    v_pk_add_f32 v[58:59], v[26:27], v[42:43] neg_lo:[0,1] neg_hi:[0,1]
    v_pk_mul_f32 v[60:61], v[44:45], v[44:45]
    v_pk_add_f32 v[62:63], v[44:45], v[46:47]
    v_pk_mul_f32 v[64:65], v[52:53], v[52:53]
    v_pk_add_f32 v[66:67], v[52:53], v[54:55]
    v_pk_fma_f32 v[60:61], v[46:47], v[46:47], v[60:61]
    v_pk_fma_f32 v[64:65], v[54:55], v[54:55], v[64:65]
    v_pk_fma_f32 v[60:61], v[48:49], v[48:49], v[60:61]
    v_pk_add_f32 v[62:63], v[62:63], v[48:49]
    v_pk_fma_f32 v[64:65], v[56:57], v[56:57], v[64:65]
    v_pk_add_f32 v[66:67], v[66:67], v[56:57]
    v_pk_fma_f32 v[60:61], v[50:51], v[50:51], v[60:61]
    v_pk_add_f32 v[62:63], v[62:63], v[50:51]
    v_pk_fma_f32 v[64:65], v[58:59], v[58:59], v[64:65]
    v_pk_add_f32 v[66:67], v[66:67], v[58:59]
    v_add_f32 v28, v62, v63
    v_add_f32 v30, v60, v61
    v_add_f32 v29, v66, v67
    v_add_f32 v31, v64, v65
    v_add_f32_dpp v28, v28, v28 quad_perm:[1,0,3,2] row_mask:0xf bank_mask:0xf
    v_add_f32_dpp v29, v29, v29 quad_perm:[1,0,3,2] row_mask:0xf bank_mask:0xf
    v_add_f32_dpp v30, v30, v30 quad_perm:[1,0,3,2] row_mask:0xf bank_mask:0xf
    v_add_f32_dpp v31, v31, v31 quad_perm:[1,0,3,2] row_mask:0xf bank_mask:0xf
    v_add_f32_dpp v28, v28, v28 quad_perm:[2,3,0,1] row_mask:0xf bank_mask:0xf
    v_add_f32_dpp v29, v29, v29 quad_perm:[2,3,0,1] row_mask:0xf bank_mask:0xf
    v_add_f32_dpp v30, v30, v30 quad_perm:[2,3,0,1] row_mask:0xf bank_mask:0xf
    v_add_f32_dpp v31, v31, v31 quad_perm:[2,3,0,1] row_mask:0xf bank_mask:0xf
    v_add_f32_dpp v28, v28, v28 row_half_mirror row_mask:0xf bank_mask:0xf
    v_add_f32_dpp v29, v29, v29 row_half_mirror row_mask:0xf bank_mask:0xf
    v_add_f32_dpp v30, v30, v30 row_half_mirror row_mask:0xf bank_mask:0xf
    v_add_f32_dpp v31, v31, v31 row_half_mirror row_mask:0xf bank_mask:0xf
    v_add_f32_dpp v28, v28, v28 row_mirror row_mask:0xf bank_mask:0xf
    v_add_f32_dpp v29, v29, v29 row_mirror row_mask:0xf bank_mask:0xf
    v_add_f32_dpp v30, v30, v30 row_mirror row_mask:0xf bank_mask:0xf
    v_add_f32_dpp v31, v31, v31 row_mirror row_mask:0xf bank_mask:0xf
    v_add_f32_dpp v28, v28, v28 row_bcast:15 row_mask:0xa bank_mask:0xf
    v_add_f32_dpp v29, v29, v29 row_bcast:15 row_mask:0xa bank_mask:0xf
    v_add_f32_dpp v30, v30, v30 row_bcast:15 row_mask:0xa bank_mask:0xf
    v_add_f32_dpp v31, v31, v31 row_bcast:15 row_mask:0xa bank_mask:0xf
    v_add_f32_dpp v28, v28, v28 row_bcast:31 row_mask:0xc bank_mask:0xf
    v_add_f32_dpp v29, v29, v29 row_bcast:31 row_mask:0xc bank_mask:0xf
    v_add_f32_dpp v30, v30, v30 row_bcast:31 row_mask:0xc bank_mask:0xf
    v_add_f32_dpp v31, v31, v31 row_bcast:31 row_mask:0xc bank_mask:0xf
    v_readlane_b32 s53, v28, 63
    v_readlane_b32 s54, v29, 63
    v_readlane_b32 s55, v30, 63
    v_readlane_b32 s3, v31, 63
    s_mov_b32 s7, 0x3b000000
    v_mov_b32 v28, s53
    v_mov_b32 v29, s54
    v_mov_b32 v30, s55
    v_mov_b32 v31, s3
    v_mul_f32 v28, s7, v28
    v_mul_f32 v30, s7, v30
    v_mul_f32 v29, s7, v29
    v_mul_f32 v31, s7, v31
    v_fma_f32 v30, -v28, v28, v30
    v_add_f32 v28, v28, v40
    v_fma_f32 v31, -v29, v29, v31
    v_add_f32 v29, v29, v42
    v_max_f32 v30, 0, v30
    v_max_f32 v31, 0, v31
    v_cvt_pk_bf16_f32 v30, v30, v30
    v_and_b32 v30, 0xffff0000, v30
    v_cvt_pk_bf16_f32 v31, v31, v31
    v_and_b32 v31, 0xffff0000, v31
    v_add_f32 v30, 0x3727c5ac, v30
    v_add_f32 v31, 0x3727c5ac, v31
    v_cvt_pk_bf16_f32 v30, v30, v30
    v_and_b32 v30, 0xffff0000, v30
    v_cvt_pk_bf16_f32 v31, v31, v31
    v_and_b32 v31, 0xffff0000, v31
    v_sqrt_f32 v30, v30
    v_sqrt_f32 v31, v31
    v_cvt_pk_bf16_f32 v28, v28, v28
    v_and_b32 v28, 0xffff0000, v28
    v_cvt_pk_bf16_f32 v29, v29, v29
    v_and_b32 v29, 0xffff0000, v29
    v_cvt_pk_bf16_f32 v30, v30, v30
    v_and_b32 v30, 0xffff0000, v30
    v_cvt_pk_bf16_f32 v31, v31, v31
    v_and_b32 v31, 0xffff0000, v31
    v_rcp_f32 v40, v30
    v_rcp_f32 v42, v31
    v_mov_b32 v44, v28
    v_mov_b32 v45, v28
    v_mov_b32 v46, v29
    v_mov_b32 v47, v29
    v_mov_b32 v41, v40
    v_mov_b32 v43, v42
    v_pk_add_f32 v[12:13], v[12:13], v[44:45] neg_lo:[0,1] neg_hi:[0,1]
    v_cvt_pk_bf16_f32 v32, v12, v13
    v_pk_add_f32 v[20:21], v[20:21], v[46:47] neg_lo:[0,1] neg_hi:[0,1]
    v_cvt_pk_bf16_f32 v33, v20, v21
    v_lshlrev_b32 v12, 16, v32
    v_and_b32 v13, 0xffff0000, v32
    v_lshlrev_b32 v20, 16, v33
    v_and_b32 v21, 0xffff0000, v33
    v_pk_mul_f32 v[12:13], v[12:13], v[40:41]
    v_cvt_pk_bf16_f32 v4, v12, v13
    v_pk_mul_f32 v[20:21], v[20:21], v[42:43]
    v_cvt_pk_bf16_f32 v8, v20, v21
    v_pk_add_f32 v[14:15], v[14:15], v[44:45] neg_lo:[0,1] neg_hi:[0,1]
    v_cvt_pk_bf16_f32 v32, v14, v15
    v_pk_add_f32 v[22:23], v[22:23], v[46:47] neg_lo:[0,1] neg_hi:[0,1]
    v_cvt_pk_bf16_f32 v33, v22, v23
    v_lshlrev_b32 v14, 16, v32
    v_and_b32 v15, 0xffff0000, v32
    v_lshlrev_b32 v22, 16, v33
    v_and_b32 v23, 0xffff0000, v33
    v_pk_mul_f32 v[14:15], v[14:15], v[40:41]
    v_cvt_pk_bf16_f32 v5, v14, v15
    v_pk_mul_f32 v[22:23], v[22:23], v[42:43]
    v_cvt_pk_bf16_f32 v9, v22, v23
    v_pk_add_f32 v[16:17], v[16:17], v[44:45] neg_lo:[0,1] neg_hi:[0,1]
    v_cvt_pk_bf16_f32 v32, v16, v17
    v_pk_add_f32 v[24:25], v[24:25], v[46:47] neg_lo:[0,1] neg_hi:[0,1]
    v_cvt_pk_bf16_f32 v33, v24, v25
    v_lshlrev_b32 v16, 16, v32
    v_and_b32 v17, 0xffff0000, v32
    v_lshlrev_b32 v24, 16, v33
    v_and_b32 v25, 0xffff0000, v33
    v_pk_mul_f32 v[16:17], v[16:17], v[40:41]
    v_cvt_pk_bf16_f32 v6, v16, v17
    v_pk_mul_f32 v[24:25], v[24:25], v[42:43]
    v_cvt_pk_bf16_f32 v10, v24, v25
    v_pk_add_f32 v[18:19], v[18:19], v[44:45] neg_lo:[0,1] neg_hi:[0,1]
    v_cvt_pk_bf16_f32 v32, v18, v19
    v_pk_add_f32 v[26:27], v[26:27], v[46:47] neg_lo:[0,1] neg_hi:[0,1]
    v_cvt_pk_bf16_f32 v33, v26, v27
    v_lshlrev_b32 v18, 16, v32
    v_and_b32 v19, 0xffff0000, v32
    v_lshlrev_b32 v26, 16, v33
    v_and_b32 v27, 0xffff0000, v33
    v_pk_mul_f32 v[18:19], v[18:19], v[40:41]
    v_cvt_pk_bf16_f32 v7, v18, v19
    v_pk_mul_f32 v[26:27], v[26:27], v[42:43]
    v_cvt_pk_bf16_f32 v11, v26, v27
    s_lshl_b32 s53, s45, 11
    s_add_u32 s53, s53, 149600
    v_add_u32 v35, s53, v3
    ds_write_b128 v35, v[4:7]
    ds_write_b128 v35, v[8:11] offset:1024
    v_mov_b32 v36, v28
    v_mov_b32 v37, v30
    v_mov_b32 v38, v29
    v_mov_b32 v39, v31
    s_lshl_b32 s53, s45, 4
    s_add_u32 s53, s53, 157792
    v_mov_b32 v35, s53
    s_mov_b64 exec, 1
    ds_write_b128 v35, v[36:39]
    s_mov_b64 exec, -1
    s_cmp_lg_u32 s45, 0
    s_cbranch_scc1 G_NN1
    v_mov_b32 v210, 0
    global_load_dword v211, v210, s[80:81] sc0 sc1
    v_mov_b32 v204, 0
    v_mov_b32 v205, 0
    v_mov_b32 v206, 0
    v_mov_b32 v207, 0
    v_mov_b32 v212, 143872
    ds_write_b128 v212, v[204:207]
    ds_write_b128 v212, v[204:207] offset:16
    ds_write_b128 v212, v[204:207] offset:32
    ds_write_b128 v212, v[204:207] offset:48
G_NN1:
    v_mov_b32 v16, v214
    v_mov_b32 v17, v215
    v_mov_b32 v18, v216
    v_mov_b32 v19, v217
    v_mov_b32 v20, v218
    s_waitcnt lgkmcnt(0)
    s_mul_i32 s53, s45, 11
    v_lshrrev_b32 v4, 3, v1
    v_and_b32 v5, 7, v1
    v_bfe_u32 v6, v4, 1, 2
    v_lshlrev_b32 v6, 1, v6
    v_xor_b32 v5, v5, v6
    v_lshlrev_b32 v4, 10, v4
    v_lshl_add_u32 v4, v5, 4, v4
    s_lshl_b32 s72, s53, 15
    s_lshl_b32 s54, s52, 7
    s_add_u32 s72, s72, s54
    s_lshl_b32 s67, s45, 12
    s_cmp_lt_u32 s45, 2
    s_mov_b32 s68, 24576
    s_cmp_lt_u32 s45, 2
    s_cselect_b32 s68, 114688, s68
    s_add_u32 s68, s68, s67
    s_lshl_b32 s74, s51, 2
    s_mul_i32 s74, s74, 43
    s_add_u32 s74, s74, s53
    s_lshl_b32 s74, s74, 10
    s_and_b32 s6, s51, 7
    s_mul_i32 s6, s6, 11
    s_lshr_b32 s6, s6, 3
    s_and_b32 s7, s52, 3
    s_mul_i32 s7, s7, 3
    s_add_u32 s6, s6, s7
    s_cmp_ge_u32 s6, 11
    s_cselect_b32 s7, 11, 0
    s_sub_u32 s6, s6, s7
    s_setprio 0
    s_barrier
    v_mov_b32 v22, v16
    v_mov_b32 v23, v17
    v_mov_b32 v24, v18
    v_mov_b32 v25, v19
    v_mov_b32 v26, v20
    ds_read_b128 v[152:155], v22 offset:0
    ds_read_b128 v[156:159], v22 offset:2048
    ds_read_b128 v[160:163], v22 offset:4096
    ds_read_b128 v[164:167], v22 offset:6144
    ds_read_b64_tr_b16 v[128:129], v24 offset:0
    ds_read_b64_tr_b16 v[130:131], v24 offset:768
    ds_read_b64_tr_b16 v[132:133], v25 offset:0
    ds_read_b64_tr_b16 v[134:135], v25 offset:768
    ds_read_b64_tr_b16 v[136:137], v26 offset:0
    ds_read_b64_tr_b16 v[138:139], v26 offset:768
    ds_read_b64_tr_b16 v[140:141], v24 offset:12288
    ds_read_b64_tr_b16 v[142:143], v24 offset:13056
    ds_read_b64_tr_b16 v[144:145], v25 offset:12288
    ds_read_b64_tr_b16 v[146:147], v25 offset:13056
    ds_read_b64_tr_b16 v[148:149], v26 offset:12288
    ds_read_b64_tr_b16 v[150:151], v26 offset:13056
    s_waitcnt lgkmcnt(10)
    v_mfma_f32_16x16x32_bf16 v[32:35], v[128:131], v[152:155], 0
    v_mfma_f32_16x16x32_bf16 v[36:39], v[128:131], v[156:159], 0
    ds_read_b128 v[192:195], v23 offset:0
    v_mfma_f32_16x16x32_bf16 v[40:43], v[128:131], v[160:163], 0
    ds_read_b128 v[196:199], v23 offset:2048
    v_mfma_f32_16x16x32_bf16 v[44:47], v[128:131], v[164:167], 0
    ds_read_b128 v[200:203], v23 offset:4096
    s_waitcnt lgkmcnt(11)
    v_mfma_f32_16x16x32_bf16 v[48:51], v[132:135], v[152:155], 0
    ds_read_b128 v[204:207], v23 offset:6144
    v_mfma_f32_16x16x32_bf16 v[52:55], v[132:135], v[156:159], 0
    ds_read_b64_tr_b16 v[168:169], v24 offset:6144
    v_mfma_f32_16x16x32_bf16 v[56:59], v[132:135], v[160:163], 0
    ds_read_b64_tr_b16 v[170:171], v24 offset:6912
    v_mfma_f32_16x16x32_bf16 v[60:63], v[132:135], v[164:167], 0
    ds_read_b64_tr_b16 v[172:173], v25 offset:6144
    s_waitcnt lgkmcnt(13)
    v_mfma_f32_16x16x32_bf16 v[64:67], v[136:139], v[152:155], 0
    ds_read_b64_tr_b16 v[174:175], v25 offset:6912
    v_mfma_f32_16x16x32_bf16 v[68:71], v[136:139], v[156:159], 0
    ds_read_b64_tr_b16 v[176:177], v26 offset:6144
    v_mfma_f32_16x16x32_bf16 v[72:75], v[136:139], v[160:163], 0
    ds_read_b64_tr_b16 v[178:179], v26 offset:6912
    v_mfma_f32_16x16x32_bf16 v[76:79], v[136:139], v[164:167], 0
    ds_read_b64_tr_b16 v[180:181], v24 offset:18432
    s_waitcnt lgkmcnt(15)
    v_mfma_f32_16x16x32_bf16 v[80:83], v[140:143], v[152:155], 0
    ds_read_b64_tr_b16 v[182:183], v24 offset:19200
    v_mfma_f32_16x16x32_bf16 v[84:87], v[140:143], v[156:159], 0
    ds_read_b64_tr_b16 v[184:185], v25 offset:18432
    v_mfma_f32_16x16x32_bf16 v[88:91], v[140:143], v[160:163], 0
    ds_read_b64_tr_b16 v[186:187], v25 offset:19200
    v_mfma_f32_16x16x32_bf16 v[92:95], v[140:143], v[164:167], 0
    ds_read_b64_tr_b16 v[188:189], v26 offset:18432
    s_waitcnt lgkmcnt(15)
    v_mfma_f32_16x16x32_bf16 v[96:99], v[144:147], v[152:155], 0
    ds_read_b64_tr_b16 v[190:191], v26 offset:19200
    v_mfma_f32_16x16x32_bf16 v[100:103], v[144:147], v[156:159], 0
    v_mfma_f32_16x16x32_bf16 v[104:107], v[144:147], v[160:163], 0
    v_mfma_f32_16x16x32_bf16 v[108:111], v[144:147], v[164:167], 0
    v_mfma_f32_16x16x32_bf16 v[112:115], v[148:151], v[152:155], 0
    v_mfma_f32_16x16x32_bf16 v[116:119], v[148:151], v[156:159], 0
    v_mfma_f32_16x16x32_bf16 v[120:123], v[148:151], v[160:163], 0
    v_mfma_f32_16x16x32_bf16 v[124:127], v[148:151], v[164:167], 0
    s_cmp_lg_u32 s45, 0
    s_cbranch_scc1 G_NN2
    s_mov_b32 s55, 200000
G_NNW:
    s_waitcnt vmcnt(0)
    v_readfirstlane_b32 s54, v211
    s_cmp_lg_u32 s54, 0
    s_cbranch_scc1 G_NNOK
    global_load_dword v211, v210, s[80:81] sc0 sc1
    s_sub_u32 s55, s55, 1
    s_cmp_lg_u32 s55, 0
    s_cbranch_scc1 G_NNW
G_NNOK:
    v_mov_b32 v208, s54
    v_mov_b32 v212, 143872
    ds_write_b32 v212, v208
G_NN2:
    s_waitcnt lgkmcnt(0)
    s_barrier
    v_add_u32 v22, 40960, v16
    v_add_u32 v23, 40960, v17
    v_add_u32 v24, 40960, v18
    v_add_u32 v25, 40960, v19
    v_add_u32 v26, 40960, v20
    v_mfma_f32_16x16x32_bf16 v[32:35], v[168:171], v[192:195], v[32:35]
    v_mfma_f32_16x16x32_bf16 v[36:39], v[168:171], v[196:199], v[36:39]
    ds_read_b128 v[152:155], v22 offset:0
    v_mfma_f32_16x16x32_bf16 v[40:43], v[168:171], v[200:203], v[40:43]
    ds_read_b128 v[156:159], v22 offset:2048
    v_mfma_f32_16x16x32_bf16 v[44:47], v[168:171], v[204:207], v[44:47]
    ds_read_b128 v[160:163], v22 offset:4096
    v_mfma_f32_16x16x32_bf16 v[48:51], v[172:175], v[192:195], v[48:51]
    ds_read_b128 v[164:167], v22 offset:6144
    v_mfma_f32_16x16x32_bf16 v[52:55], v[172:175], v[196:199], v[52:55]
    ds_read_b64_tr_b16 v[128:129], v24 offset:0
    v_mfma_f32_16x16x32_bf16 v[56:59], v[172:175], v[200:203], v[56:59]
    ds_read_b64_tr_b16 v[130:131], v24 offset:768
    v_mfma_f32_16x16x32_bf16 v[60:63], v[172:175], v[204:207], v[60:63]
    ds_read_b64_tr_b16 v[132:133], v25 offset:0
    v_mfma_f32_16x16x32_bf16 v[64:67], v[176:179], v[192:195], v[64:67]
    ds_read_b64_tr_b16 v[134:135], v25 offset:768
    v_mfma_f32_16x16x32_bf16 v[68:71], v[176:179], v[196:199], v[68:71]
    ds_read_b64_tr_b16 v[136:137], v26 offset:0
    v_mfma_f32_16x16x32_bf16 v[72:75], v[176:179], v[200:203], v[72:75]
    ds_read_b64_tr_b16 v[138:139], v26 offset:768
    v_mfma_f32_16x16x32_bf16 v[76:79], v[176:179], v[204:207], v[76:79]
    ds_read_b64_tr_b16 v[140:141], v24 offset:12288
    v_mfma_f32_16x16x32_bf16 v[80:83], v[180:183], v[192:195], v[80:83]
    ds_read_b64_tr_b16 v[142:143], v24 offset:13056
    v_mfma_f32_16x16x32_bf16 v[84:87], v[180:183], v[196:199], v[84:87]
    ds_read_b64_tr_b16 v[144:145], v25 offset:12288
    v_mfma_f32_16x16x32_bf16 v[88:91], v[180:183], v[200:203], v[88:91]
    ds_read_b64_tr_b16 v[146:147], v25 offset:13056
    v_mfma_f32_16x16x32_bf16 v[92:95], v[180:183], v[204:207], v[92:95]
    ds_read_b64_tr_b16 v[148:149], v26 offset:12288
    v_mfma_f32_16x16x32_bf16 v[96:99], v[184:187], v[192:195], v[96:99]
    ds_read_b64_tr_b16 v[150:151], v26 offset:13056
    v_mfma_f32_16x16x32_bf16 v[100:103], v[184:187], v[196:199], v[100:103]
    v_mfma_f32_16x16x32_bf16 v[104:107], v[184:187], v[200:203], v[104:107]
    v_mfma_f32_16x16x32_bf16 v[108:111], v[184:187], v[204:207], v[108:111]
    v_mfma_f32_16x16x32_bf16 v[112:115], v[188:191], v[192:195], v[112:115]
    v_mfma_f32_16x16x32_bf16 v[116:119], v[188:191], v[196:199], v[116:119]
    v_mfma_f32_16x16x32_bf16 v[120:123], v[188:191], v[200:203], v[120:123]
    v_mfma_f32_16x16x32_bf16 v[124:127], v[188:191], v[204:207], v[124:127]
    s_waitcnt lgkmcnt(10)
    v_mfma_f32_16x16x32_bf16 v[32:35], v[128:131], v[152:155], v[32:35]
    v_mfma_f32_16x16x32_bf16 v[36:39], v[128:131], v[156:159], v[36:39]
    ds_read_b128 v[192:195], v23 offset:0
    v_mfma_f32_16x16x32_bf16 v[40:43], v[128:131], v[160:163], v[40:43]
    ds_read_b128 v[196:199], v23 offset:2048
    v_mfma_f32_16x16x32_bf16 v[44:47], v[128:131], v[164:167], v[44:47]
    ds_read_b128 v[200:203], v23 offset:4096
    s_waitcnt lgkmcnt(11)
    v_mfma_f32_16x16x32_bf16 v[48:51], v[132:135], v[152:155], v[48:51]
    ds_read_b128 v[204:207], v23 offset:6144
    v_mfma_f32_16x16x32_bf16 v[52:55], v[132:135], v[156:159], v[52:55]
    ds_read_b64_tr_b16 v[168:169], v24 offset:6144
    v_mfma_f32_16x16x32_bf16 v[56:59], v[132:135], v[160:163], v[56:59]
    ds_read_b64_tr_b16 v[170:171], v24 offset:6912
    v_mfma_f32_16x16x32_bf16 v[60:63], v[132:135], v[164:167], v[60:63]
    ds_read_b64_tr_b16 v[172:173], v25 offset:6144
    s_waitcnt lgkmcnt(13)
    v_mfma_f32_16x16x32_bf16 v[64:67], v[136:139], v[152:155], v[64:67]
    ds_read_b64_tr_b16 v[174:175], v25 offset:6912
    v_mfma_f32_16x16x32_bf16 v[68:71], v[136:139], v[156:159], v[68:71]
    ds_read_b64_tr_b16 v[176:177], v26 offset:6144
    v_mfma_f32_16x16x32_bf16 v[72:75], v[136:139], v[160:163], v[72:75]
    ds_read_b64_tr_b16 v[178:179], v26 offset:6912
    v_mfma_f32_16x16x32_bf16 v[76:79], v[136:139], v[164:167], v[76:79]
    ds_read_b64_tr_b16 v[180:181], v24 offset:18432
    s_waitcnt lgkmcnt(15)
    v_mfma_f32_16x16x32_bf16 v[80:83], v[140:143], v[152:155], v[80:83]
    ds_read_b64_tr_b16 v[182:183], v24 offset:19200
    v_mfma_f32_16x16x32_bf16 v[84:87], v[140:143], v[156:159], v[84:87]
    ds_read_b64_tr_b16 v[184:185], v25 offset:18432
    v_mfma_f32_16x16x32_bf16 v[88:91], v[140:143], v[160:163], v[88:91]
    ds_read_b64_tr_b16 v[186:187], v25 offset:19200
    v_mfma_f32_16x16x32_bf16 v[92:95], v[140:143], v[164:167], v[92:95]
    ds_read_b64_tr_b16 v[188:189], v26 offset:18432
    s_waitcnt lgkmcnt(15)
    v_mfma_f32_16x16x32_bf16 v[96:99], v[144:147], v[152:155], v[96:99]
    ds_read_b64_tr_b16 v[190:191], v26 offset:19200
    v_mfma_f32_16x16x32_bf16 v[100:103], v[144:147], v[156:159], v[100:103]
    v_mfma_f32_16x16x32_bf16 v[104:107], v[144:147], v[160:163], v[104:107]
    v_mfma_f32_16x16x32_bf16 v[108:111], v[144:147], v[164:167], v[108:111]
    v_mfma_f32_16x16x32_bf16 v[112:115], v[148:151], v[152:155], v[112:115]
    v_mfma_f32_16x16x32_bf16 v[116:119], v[148:151], v[156:159], v[116:119]
    v_mfma_f32_16x16x32_bf16 v[120:123], v[148:151], v[160:163], v[120:123]
    v_mfma_f32_16x16x32_bf16 v[124:127], v[148:151], v[164:167], v[124:127]
    s_waitcnt lgkmcnt(0)
    s_barrier
    v_add_u32 v22, 81920, v16
    v_add_u32 v23, 81920, v17
    v_add_u32 v24, 81920, v18
    v_add_u32 v25, 81920, v19
    v_add_u32 v26, 81920, v20
    v_mfma_f32_16x16x32_bf16 v[32:35], v[168:171], v[192:195], v[32:35]
    v_mfma_f32_16x16x32_bf16 v[36:39], v[168:171], v[196:199], v[36:39]
    ds_read_b128 v[152:155], v22 offset:0
    v_mfma_f32_16x16x32_bf16 v[40:43], v[168:171], v[200:203], v[40:43]
    ds_read_b128 v[156:159], v22 offset:2048
    v_mfma_f32_16x16x32_bf16 v[44:47], v[168:171], v[204:207], v[44:47]
    ds_read_b128 v[160:163], v22 offset:4096
    v_mfma_f32_16x16x32_bf16 v[48:51], v[172:175], v[192:195], v[48:51]
    ds_read_b128 v[164:167], v22 offset:6144
    v_mfma_f32_16x16x32_bf16 v[52:55], v[172:175], v[196:199], v[52:55]
    ds_read_b64_tr_b16 v[128:129], v24 offset:0
    v_mfma_f32_16x16x32_bf16 v[56:59], v[172:175], v[200:203], v[56:59]
    ds_read_b64_tr_b16 v[130:131], v24 offset:768
    v_mfma_f32_16x16x32_bf16 v[60:63], v[172:175], v[204:207], v[60:63]
    ds_read_b64_tr_b16 v[132:133], v25 offset:0
    v_mfma_f32_16x16x32_bf16 v[64:67], v[176:179], v[192:195], v[64:67]
    ds_read_b64_tr_b16 v[134:135], v25 offset:768
    v_mfma_f32_16x16x32_bf16 v[68:71], v[176:179], v[196:199], v[68:71]
    ds_read_b64_tr_b16 v[136:137], v26 offset:0
    v_mfma_f32_16x16x32_bf16 v[72:75], v[176:179], v[200:203], v[72:75]
    ds_read_b64_tr_b16 v[138:139], v26 offset:768
    v_mfma_f32_16x16x32_bf16 v[76:79], v[176:179], v[204:207], v[76:79]
    ds_read_b64_tr_b16 v[140:141], v24 offset:12288
    v_mfma_f32_16x16x32_bf16 v[80:83], v[180:183], v[192:195], v[80:83]
    ds_read_b64_tr_b16 v[142:143], v24 offset:13056
    v_mfma_f32_16x16x32_bf16 v[84:87], v[180:183], v[196:199], v[84:87]
    ds_read_b64_tr_b16 v[144:145], v25 offset:12288
    v_mfma_f32_16x16x32_bf16 v[88:91], v[180:183], v[200:203], v[88:91]
    ds_read_b64_tr_b16 v[146:147], v25 offset:13056
    v_mfma_f32_16x16x32_bf16 v[92:95], v[180:183], v[204:207], v[92:95]
    ds_read_b64_tr_b16 v[148:149], v26 offset:12288
    v_mfma_f32_16x16x32_bf16 v[96:99], v[184:187], v[192:195], v[96:99]
    ds_read_b64_tr_b16 v[150:151], v26 offset:13056
    v_mfma_f32_16x16x32_bf16 v[100:103], v[184:187], v[196:199], v[100:103]
    v_mfma_f32_16x16x32_bf16 v[104:107], v[184:187], v[200:203], v[104:107]
    v_mfma_f32_16x16x32_bf16 v[108:111], v[184:187], v[204:207], v[108:111]
    v_mfma_f32_16x16x32_bf16 v[112:115], v[188:191], v[192:195], v[112:115]
    v_mfma_f32_16x16x32_bf16 v[116:119], v[188:191], v[196:199], v[116:119]
    v_mfma_f32_16x16x32_bf16 v[120:123], v[188:191], v[200:203], v[120:123]
    v_mfma_f32_16x16x32_bf16 v[124:127], v[188:191], v[204:207], v[124:127]
    s_waitcnt lgkmcnt(10)
    v_mfma_f32_16x16x32_bf16 v[32:35], v[128:131], v[152:155], v[32:35]
    v_mfma_f32_16x16x32_bf16 v[36:39], v[128:131], v[156:159], v[36:39]
    ds_read_b128 v[192:195], v23 offset:0
    v_mfma_f32_16x16x32_bf16 v[40:43], v[128:131], v[160:163], v[40:43]
    ds_read_b128 v[196:199], v23 offset:2048
    v_mfma_f32_16x16x32_bf16 v[44:47], v[128:131], v[164:167], v[44:47]
    ds_read_b128 v[200:203], v23 offset:4096
    s_waitcnt lgkmcnt(11)
    v_mfma_f32_16x16x32_bf16 v[48:51], v[132:135], v[152:155], v[48:51]
    ds_read_b128 v[204:207], v23 offset:6144
    v_mfma_f32_16x16x32_bf16 v[52:55], v[132:135], v[156:159], v[52:55]
    ds_read_b64_tr_b16 v[168:169], v24 offset:6144
    v_mfma_f32_16x16x32_bf16 v[56:59], v[132:135], v[160:163], v[56:59]
    ds_read_b64_tr_b16 v[170:171], v24 offset:6912
    v_mfma_f32_16x16x32_bf16 v[60:63], v[132:135], v[164:167], v[60:63]
    ds_read_b64_tr_b16 v[172:173], v25 offset:6144
    s_waitcnt lgkmcnt(13)
    v_mfma_f32_16x16x32_bf16 v[64:67], v[136:139], v[152:155], v[64:67]
    ds_read_b64_tr_b16 v[174:175], v25 offset:6912
    v_mfma_f32_16x16x32_bf16 v[68:71], v[136:139], v[156:159], v[68:71]
    ds_read_b64_tr_b16 v[176:177], v26 offset:6144
    v_mfma_f32_16x16x32_bf16 v[72:75], v[136:139], v[160:163], v[72:75]
    ds_read_b64_tr_b16 v[178:179], v26 offset:6912
    v_mfma_f32_16x16x32_bf16 v[76:79], v[136:139], v[164:167], v[76:79]
    ds_read_b64_tr_b16 v[180:181], v24 offset:18432
    s_waitcnt lgkmcnt(15)
    v_mfma_f32_16x16x32_bf16 v[80:83], v[140:143], v[152:155], v[80:83]
    ds_read_b64_tr_b16 v[182:183], v24 offset:19200
    v_mfma_f32_16x16x32_bf16 v[84:87], v[140:143], v[156:159], v[84:87]
    ds_read_b64_tr_b16 v[184:185], v25 offset:18432
    v_mfma_f32_16x16x32_bf16 v[88:91], v[140:143], v[160:163], v[88:91]
    ds_read_b64_tr_b16 v[186:187], v25 offset:19200
    v_mfma_f32_16x16x32_bf16 v[92:95], v[140:143], v[164:167], v[92:95]
    ds_read_b64_tr_b16 v[188:189], v26 offset:18432
    s_waitcnt lgkmcnt(15)
    v_mfma_f32_16x16x32_bf16 v[96:99], v[144:147], v[152:155], v[96:99]
    ds_read_b64_tr_b16 v[190:191], v26 offset:19200
    v_mfma_f32_16x16x32_bf16 v[100:103], v[144:147], v[156:159], v[100:103]
    v_mfma_f32_16x16x32_bf16 v[104:107], v[144:147], v[160:163], v[104:107]
    v_mfma_f32_16x16x32_bf16 v[108:111], v[144:147], v[164:167], v[108:111]
    v_mfma_f32_16x16x32_bf16 v[112:115], v[148:151], v[152:155], v[112:115]
    v_mfma_f32_16x16x32_bf16 v[116:119], v[148:151], v[156:159], v[116:119]
    v_mfma_f32_16x16x32_bf16 v[120:123], v[148:151], v[160:163], v[120:123]
    v_mfma_f32_16x16x32_bf16 v[124:127], v[148:151], v[164:167], v[124:127]
    s_waitcnt lgkmcnt(0)
    s_barrier
    v_mov_b32 v22, v16
    v_mov_b32 v23, v17
    v_mov_b32 v24, v18
    v_mov_b32 v25, v19
    v_mov_b32 v26, v20
    v_mfma_f32_16x16x32_bf16 v[32:35], v[168:171], v[192:195], v[32:35]
    v_mfma_f32_16x16x32_bf16 v[36:39], v[168:171], v[196:199], v[36:39]
    ds_read_b128 v[152:155], v22 offset:0
    v_mfma_f32_16x16x32_bf16 v[40:43], v[168:171], v[200:203], v[40:43]
    ds_read_b128 v[156:159], v22 offset:2048
    v_mfma_f32_16x16x32_bf16 v[44:47], v[168:171], v[204:207], v[44:47]
    ds_read_b128 v[160:163], v22 offset:4096
    v_mfma_f32_16x16x32_bf16 v[48:51], v[172:175], v[192:195], v[48:51]
    ds_read_b128 v[164:167], v22 offset:6144
    v_mfma_f32_16x16x32_bf16 v[52:55], v[172:175], v[196:199], v[52:55]
    ds_read_b64_tr_b16 v[128:129], v24 offset:0
    v_mfma_f32_16x16x32_bf16 v[56:59], v[172:175], v[200:203], v[56:59]
    ds_read_b64_tr_b16 v[130:131], v24 offset:768
    v_mfma_f32_16x16x32_bf16 v[60:63], v[172:175], v[204:207], v[60:63]
    ds_read_b64_tr_b16 v[132:133], v25 offset:0
    v_mfma_f32_16x16x32_bf16 v[64:67], v[176:179], v[192:195], v[64:67]
    ds_read_b64_tr_b16 v[134:135], v25 offset:768
    v_mfma_f32_16x16x32_bf16 v[68:71], v[176:179], v[196:199], v[68:71]
    ds_read_b64_tr_b16 v[136:137], v26 offset:0
    v_mfma_f32_16x16x32_bf16 v[72:75], v[176:179], v[200:203], v[72:75]
    ds_read_b64_tr_b16 v[138:139], v26 offset:768
    v_mfma_f32_16x16x32_bf16 v[76:79], v[176:179], v[204:207], v[76:79]
    ds_read_b64_tr_b16 v[140:141], v24 offset:12288
    v_mfma_f32_16x16x32_bf16 v[80:83], v[180:183], v[192:195], v[80:83]
    ds_read_b64_tr_b16 v[142:143], v24 offset:13056
    v_mfma_f32_16x16x32_bf16 v[84:87], v[180:183], v[196:199], v[84:87]
    ds_read_b64_tr_b16 v[144:145], v25 offset:12288
    v_mfma_f32_16x16x32_bf16 v[88:91], v[180:183], v[200:203], v[88:91]
    ds_read_b64_tr_b16 v[146:147], v25 offset:13056
    v_mfma_f32_16x16x32_bf16 v[92:95], v[180:183], v[204:207], v[92:95]
    ds_read_b64_tr_b16 v[148:149], v26 offset:12288
    v_mfma_f32_16x16x32_bf16 v[96:99], v[184:187], v[192:195], v[96:99]
    ds_read_b64_tr_b16 v[150:151], v26 offset:13056
    v_mfma_f32_16x16x32_bf16 v[100:103], v[184:187], v[196:199], v[100:103]
    v_mfma_f32_16x16x32_bf16 v[104:107], v[184:187], v[200:203], v[104:107]
    v_mfma_f32_16x16x32_bf16 v[108:111], v[184:187], v[204:207], v[108:111]
    v_mfma_f32_16x16x32_bf16 v[112:115], v[188:191], v[192:195], v[112:115]
    v_mfma_f32_16x16x32_bf16 v[116:119], v[188:191], v[196:199], v[116:119]
    v_mfma_f32_16x16x32_bf16 v[120:123], v[188:191], v[200:203], v[120:123]
    v_mfma_f32_16x16x32_bf16 v[124:127], v[188:191], v[204:207], v[124:127]
    s_waitcnt lgkmcnt(10)
    v_mfma_f32_16x16x32_bf16 v[32:35], v[128:131], v[152:155], v[32:35]
    v_mfma_f32_16x16x32_bf16 v[36:39], v[128:131], v[156:159], v[36:39]
    ds_read_b128 v[192:195], v23 offset:0
    v_mfma_f32_16x16x32_bf16 v[40:43], v[128:131], v[160:163], v[40:43]
    ds_read_b128 v[196:199], v23 offset:2048
    v_mfma_f32_16x16x32_bf16 v[44:47], v[128:131], v[164:167], v[44:47]
    ds_read_b128 v[200:203], v23 offset:4096
    s_waitcnt lgkmcnt(11)
    v_mfma_f32_16x16x32_bf16 v[48:51], v[132:135], v[152:155], v[48:51]
    ds_read_b128 v[204:207], v23 offset:6144
    v_mfma_f32_16x16x32_bf16 v[52:55], v[132:135], v[156:159], v[52:55]
    ds_read_b64_tr_b16 v[168:169], v24 offset:6144
    v_mfma_f32_16x16x32_bf16 v[56:59], v[132:135], v[160:163], v[56:59]
    ds_read_b64_tr_b16 v[170:171], v24 offset:6912
    v_mfma_f32_16x16x32_bf16 v[60:63], v[132:135], v[164:167], v[60:63]
    ds_read_b64_tr_b16 v[172:173], v25 offset:6144
    s_waitcnt lgkmcnt(13)
    v_mfma_f32_16x16x32_bf16 v[64:67], v[136:139], v[152:155], v[64:67]
    ds_read_b64_tr_b16 v[174:175], v25 offset:6912
    v_mfma_f32_16x16x32_bf16 v[68:71], v[136:139], v[156:159], v[68:71]
    ds_read_b64_tr_b16 v[176:177], v26 offset:6144
    v_mfma_f32_16x16x32_bf16 v[72:75], v[136:139], v[160:163], v[72:75]
    ds_read_b64_tr_b16 v[178:179], v26 offset:6912
    v_mfma_f32_16x16x32_bf16 v[76:79], v[136:139], v[164:167], v[76:79]
    ds_read_b64_tr_b16 v[180:181], v24 offset:18432
    s_waitcnt lgkmcnt(15)
    v_mfma_f32_16x16x32_bf16 v[80:83], v[140:143], v[152:155], v[80:83]
    ds_read_b64_tr_b16 v[182:183], v24 offset:19200
    v_mfma_f32_16x16x32_bf16 v[84:87], v[140:143], v[156:159], v[84:87]
    ds_read_b64_tr_b16 v[184:185], v25 offset:18432
    v_mfma_f32_16x16x32_bf16 v[88:91], v[140:143], v[160:163], v[88:91]
    ds_read_b64_tr_b16 v[186:187], v25 offset:19200
    v_mfma_f32_16x16x32_bf16 v[92:95], v[140:143], v[164:167], v[92:95]
    ds_read_b64_tr_b16 v[188:189], v26 offset:18432
    s_waitcnt lgkmcnt(15)
    v_mfma_f32_16x16x32_bf16 v[96:99], v[144:147], v[152:155], v[96:99]
    ds_read_b64_tr_b16 v[190:191], v26 offset:19200
    v_mfma_f32_16x16x32_bf16 v[100:103], v[144:147], v[156:159], v[100:103]
    v_mfma_f32_16x16x32_bf16 v[104:107], v[144:147], v[160:163], v[104:107]
    v_mfma_f32_16x16x32_bf16 v[108:111], v[144:147], v[164:167], v[108:111]
    v_mfma_f32_16x16x32_bf16 v[112:115], v[148:151], v[152:155], v[112:115]
    v_mfma_f32_16x16x32_bf16 v[116:119], v[148:151], v[156:159], v[116:119]
    v_mfma_f32_16x16x32_bf16 v[120:123], v[148:151], v[160:163], v[120:123]
    v_mfma_f32_16x16x32_bf16 v[124:127], v[148:151], v[164:167], v[124:127]
    s_waitcnt lgkmcnt(0)
    s_barrier
    v_add_u32 v22, 40960, v16
    v_add_u32 v23, 40960, v17
    v_add_u32 v24, 40960, v18
    v_add_u32 v25, 40960, v19
    v_add_u32 v26, 40960, v20
    v_mfma_f32_16x16x32_bf16 v[32:35], v[168:171], v[192:195], v[32:35]
    v_mfma_f32_16x16x32_bf16 v[36:39], v[168:171], v[196:199], v[36:39]
    ds_read_b128 v[152:155], v22 offset:0
    v_mfma_f32_16x16x32_bf16 v[40:43], v[168:171], v[200:203], v[40:43]
    ds_read_b128 v[156:159], v22 offset:2048
    v_mfma_f32_16x16x32_bf16 v[44:47], v[168:171], v[204:207], v[44:47]
    ds_read_b128 v[160:163], v22 offset:4096
    v_mfma_f32_16x16x32_bf16 v[48:51], v[172:175], v[192:195], v[48:51]
    ds_read_b128 v[164:167], v22 offset:6144
    v_mfma_f32_16x16x32_bf16 v[52:55], v[172:175], v[196:199], v[52:55]
    ds_read_b64_tr_b16 v[128:129], v24 offset:0
    v_mfma_f32_16x16x32_bf16 v[56:59], v[172:175], v[200:203], v[56:59]
    ds_read_b64_tr_b16 v[130:131], v24 offset:768
    v_mfma_f32_16x16x32_bf16 v[60:63], v[172:175], v[204:207], v[60:63]
    ds_read_b64_tr_b16 v[132:133], v25 offset:0
    v_mfma_f32_16x16x32_bf16 v[64:67], v[176:179], v[192:195], v[64:67]
    ds_read_b64_tr_b16 v[134:135], v25 offset:768
    v_mfma_f32_16x16x32_bf16 v[68:71], v[176:179], v[196:199], v[68:71]
    ds_read_b64_tr_b16 v[136:137], v26 offset:0
    v_mfma_f32_16x16x32_bf16 v[72:75], v[176:179], v[200:203], v[72:75]
    ds_read_b64_tr_b16 v[138:139], v26 offset:768
    v_mfma_f32_16x16x32_bf16 v[76:79], v[176:179], v[204:207], v[76:79]
    ds_read_b64_tr_b16 v[140:141], v24 offset:12288
    v_mfma_f32_16x16x32_bf16 v[80:83], v[180:183], v[192:195], v[80:83]
    ds_read_b64_tr_b16 v[142:143], v24 offset:13056
    v_mfma_f32_16x16x32_bf16 v[84:87], v[180:183], v[196:199], v[84:87]
    ds_read_b64_tr_b16 v[144:145], v25 offset:12288
    v_mfma_f32_16x16x32_bf16 v[88:91], v[180:183], v[200:203], v[88:91]
    ds_read_b64_tr_b16 v[146:147], v25 offset:13056
    v_mfma_f32_16x16x32_bf16 v[92:95], v[180:183], v[204:207], v[92:95]
    ds_read_b64_tr_b16 v[148:149], v26 offset:12288
    v_mfma_f32_16x16x32_bf16 v[96:99], v[184:187], v[192:195], v[96:99]
    ds_read_b64_tr_b16 v[150:151], v26 offset:13056
    v_mfma_f32_16x16x32_bf16 v[100:103], v[184:187], v[196:199], v[100:103]
    v_mfma_f32_16x16x32_bf16 v[104:107], v[184:187], v[200:203], v[104:107]
    v_mfma_f32_16x16x32_bf16 v[108:111], v[184:187], v[204:207], v[108:111]
    v_mfma_f32_16x16x32_bf16 v[112:115], v[188:191], v[192:195], v[112:115]
    v_mfma_f32_16x16x32_bf16 v[116:119], v[188:191], v[196:199], v[116:119]
    v_mfma_f32_16x16x32_bf16 v[120:123], v[188:191], v[200:203], v[120:123]
    v_mfma_f32_16x16x32_bf16 v[124:127], v[188:191], v[204:207], v[124:127]
    s_waitcnt lgkmcnt(10)
    v_mfma_f32_16x16x32_bf16 v[32:35], v[128:131], v[152:155], v[32:35]
    v_mfma_f32_16x16x32_bf16 v[36:39], v[128:131], v[156:159], v[36:39]
    ds_read_b128 v[192:195], v23 offset:0
    v_mfma_f32_16x16x32_bf16 v[40:43], v[128:131], v[160:163], v[40:43]
    ds_read_b128 v[196:199], v23 offset:2048
    v_mfma_f32_16x16x32_bf16 v[44:47], v[128:131], v[164:167], v[44:47]
    ds_read_b128 v[200:203], v23 offset:4096
    s_waitcnt lgkmcnt(11)
    v_mfma_f32_16x16x32_bf16 v[48:51], v[132:135], v[152:155], v[48:51]
    ds_read_b128 v[204:207], v23 offset:6144
    v_mfma_f32_16x16x32_bf16 v[52:55], v[132:135], v[156:159], v[52:55]
    ds_read_b64_tr_b16 v[168:169], v24 offset:6144
    v_mfma_f32_16x16x32_bf16 v[56:59], v[132:135], v[160:163], v[56:59]
    ds_read_b64_tr_b16 v[170:171], v24 offset:6912
    v_mfma_f32_16x16x32_bf16 v[60:63], v[132:135], v[164:167], v[60:63]
    ds_read_b64_tr_b16 v[172:173], v25 offset:6144
    s_waitcnt lgkmcnt(13)
    v_mfma_f32_16x16x32_bf16 v[64:67], v[136:139], v[152:155], v[64:67]
    ds_read_b64_tr_b16 v[174:175], v25 offset:6912
    v_mfma_f32_16x16x32_bf16 v[68:71], v[136:139], v[156:159], v[68:71]
    ds_read_b64_tr_b16 v[176:177], v26 offset:6144
    v_mfma_f32_16x16x32_bf16 v[72:75], v[136:139], v[160:163], v[72:75]
    ds_read_b64_tr_b16 v[178:179], v26 offset:6912
    v_mfma_f32_16x16x32_bf16 v[76:79], v[136:139], v[164:167], v[76:79]
    ds_read_b64_tr_b16 v[180:181], v24 offset:18432
    s_waitcnt lgkmcnt(15)
    v_mfma_f32_16x16x32_bf16 v[80:83], v[140:143], v[152:155], v[80:83]
    ds_read_b64_tr_b16 v[182:183], v24 offset:19200
    v_mfma_f32_16x16x32_bf16 v[84:87], v[140:143], v[156:159], v[84:87]
    ds_read_b64_tr_b16 v[184:185], v25 offset:18432
    v_mfma_f32_16x16x32_bf16 v[88:91], v[140:143], v[160:163], v[88:91]
    ds_read_b64_tr_b16 v[186:187], v25 offset:19200
    v_mfma_f32_16x16x32_bf16 v[92:95], v[140:143], v[164:167], v[92:95]
    ds_read_b64_tr_b16 v[188:189], v26 offset:18432
    s_waitcnt lgkmcnt(15)
    v_mfma_f32_16x16x32_bf16 v[96:99], v[144:147], v[152:155], v[96:99]
    ds_read_b64_tr_b16 v[190:191], v26 offset:19200
    v_mfma_f32_16x16x32_bf16 v[100:103], v[144:147], v[156:159], v[100:103]
    v_mfma_f32_16x16x32_bf16 v[104:107], v[144:147], v[160:163], v[104:107]
    v_mfma_f32_16x16x32_bf16 v[108:111], v[144:147], v[164:167], v[108:111]
    v_mfma_f32_16x16x32_bf16 v[112:115], v[148:151], v[152:155], v[112:115]
    v_mfma_f32_16x16x32_bf16 v[116:119], v[148:151], v[156:159], v[116:119]
    v_mfma_f32_16x16x32_bf16 v[120:123], v[148:151], v[160:163], v[120:123]
    v_mfma_f32_16x16x32_bf16 v[124:127], v[148:151], v[164:167], v[124:127]
    s_waitcnt vmcnt(0) lgkmcnt(0)
    s_barrier
    v_add_u32 v22, 81920, v16
    v_add_u32 v23, 81920, v17
    v_add_u32 v24, 81920, v18
    v_add_u32 v25, 81920, v19
    v_add_u32 v26, 81920, v20
    v_mfma_f32_16x16x32_bf16 v[32:35], v[168:171], v[192:195], v[32:35]
    v_mfma_f32_16x16x32_bf16 v[36:39], v[168:171], v[196:199], v[36:39]
    ds_read_b128 v[152:155], v22 offset:0
    v_mfma_f32_16x16x32_bf16 v[40:43], v[168:171], v[200:203], v[40:43]
    ds_read_b128 v[156:159], v22 offset:2048
    v_mfma_f32_16x16x32_bf16 v[44:47], v[168:171], v[204:207], v[44:47]
    ds_read_b128 v[160:163], v22 offset:4096
    v_mfma_f32_16x16x32_bf16 v[48:51], v[172:175], v[192:195], v[48:51]
    ds_read_b128 v[164:167], v22 offset:6144
    v_mfma_f32_16x16x32_bf16 v[52:55], v[172:175], v[196:199], v[52:55]
    ds_read_b64_tr_b16 v[128:129], v24 offset:0
    v_mfma_f32_16x16x32_bf16 v[56:59], v[172:175], v[200:203], v[56:59]
    ds_read_b64_tr_b16 v[130:131], v24 offset:768
    v_mfma_f32_16x16x32_bf16 v[60:63], v[172:175], v[204:207], v[60:63]
    ds_read_b64_tr_b16 v[132:133], v25 offset:0
    v_mfma_f32_16x16x32_bf16 v[64:67], v[176:179], v[192:195], v[64:67]
    ds_read_b64_tr_b16 v[134:135], v25 offset:768
    v_mfma_f32_16x16x32_bf16 v[68:71], v[176:179], v[196:199], v[68:71]
    ds_read_b64_tr_b16 v[136:137], v26 offset:0
    v_mfma_f32_16x16x32_bf16 v[72:75], v[176:179], v[200:203], v[72:75]
    ds_read_b64_tr_b16 v[138:139], v26 offset:768
    v_mfma_f32_16x16x32_bf16 v[76:79], v[176:179], v[204:207], v[76:79]
    ds_read_b64_tr_b16 v[140:141], v24 offset:12288
    v_mfma_f32_16x16x32_bf16 v[80:83], v[180:183], v[192:195], v[80:83]
    ds_read_b64_tr_b16 v[142:143], v24 offset:13056
    v_mfma_f32_16x16x32_bf16 v[84:87], v[180:183], v[196:199], v[84:87]
    ds_read_b64_tr_b16 v[144:145], v25 offset:12288
    v_mfma_f32_16x16x32_bf16 v[88:91], v[180:183], v[200:203], v[88:91]
    ds_read_b64_tr_b16 v[146:147], v25 offset:13056
    v_mfma_f32_16x16x32_bf16 v[92:95], v[180:183], v[204:207], v[92:95]
    ds_read_b64_tr_b16 v[148:149], v26 offset:12288
    v_mfma_f32_16x16x32_bf16 v[96:99], v[184:187], v[192:195], v[96:99]
    ds_read_b64_tr_b16 v[150:151], v26 offset:13056
    v_mfma_f32_16x16x32_bf16 v[100:103], v[184:187], v[196:199], v[100:103]
    v_mfma_f32_16x16x32_bf16 v[104:107], v[184:187], v[200:203], v[104:107]
    v_mfma_f32_16x16x32_bf16 v[108:111], v[184:187], v[204:207], v[108:111]
    v_mfma_f32_16x16x32_bf16 v[112:115], v[188:191], v[192:195], v[112:115]
    v_mfma_f32_16x16x32_bf16 v[116:119], v[188:191], v[196:199], v[116:119]
    v_mfma_f32_16x16x32_bf16 v[120:123], v[188:191], v[200:203], v[120:123]
    v_mfma_f32_16x16x32_bf16 v[124:127], v[188:191], v[204:207], v[124:127]
    s_waitcnt lgkmcnt(10)
    v_mfma_f32_16x16x32_bf16 v[32:35], v[128:131], v[152:155], v[32:35]
    v_mfma_f32_16x16x32_bf16 v[36:39], v[128:131], v[156:159], v[36:39]
    ds_read_b128 v[192:195], v23 offset:0
    v_mfma_f32_16x16x32_bf16 v[40:43], v[128:131], v[160:163], v[40:43]
    ds_read_b128 v[196:199], v23 offset:2048
    v_mfma_f32_16x16x32_bf16 v[44:47], v[128:131], v[164:167], v[44:47]
    ds_read_b128 v[200:203], v23 offset:4096
    s_waitcnt lgkmcnt(11)
    v_mfma_f32_16x16x32_bf16 v[48:51], v[132:135], v[152:155], v[48:51]
    ds_read_b128 v[204:207], v23 offset:6144
    v_mfma_f32_16x16x32_bf16 v[52:55], v[132:135], v[156:159], v[52:55]
    ds_read_b64_tr_b16 v[168:169], v24 offset:6144
    v_mfma_f32_16x16x32_bf16 v[56:59], v[132:135], v[160:163], v[56:59]
    ds_read_b64_tr_b16 v[170:171], v24 offset:6912
    v_mfma_f32_16x16x32_bf16 v[60:63], v[132:135], v[164:167], v[60:63]
    ds_read_b64_tr_b16 v[172:173], v25 offset:6144
    s_waitcnt lgkmcnt(13)
    v_mfma_f32_16x16x32_bf16 v[64:67], v[136:139], v[152:155], v[64:67]
    ds_read_b64_tr_b16 v[174:175], v25 offset:6912
    v_mfma_f32_16x16x32_bf16 v[68:71], v[136:139], v[156:159], v[68:71]
    ds_read_b64_tr_b16 v[176:177], v26 offset:6144
    v_mfma_f32_16x16x32_bf16 v[72:75], v[136:139], v[160:163], v[72:75]
    ds_read_b64_tr_b16 v[178:179], v26 offset:6912
    v_mfma_f32_16x16x32_bf16 v[76:79], v[136:139], v[164:167], v[76:79]
    ds_read_b64_tr_b16 v[180:181], v24 offset:18432
    s_waitcnt lgkmcnt(15)
    v_mfma_f32_16x16x32_bf16 v[80:83], v[140:143], v[152:155], v[80:83]
    ds_read_b64_tr_b16 v[182:183], v24 offset:19200
    v_mfma_f32_16x16x32_bf16 v[84:87], v[140:143], v[156:159], v[84:87]
    ds_read_b64_tr_b16 v[184:185], v25 offset:18432
    v_mfma_f32_16x16x32_bf16 v[88:91], v[140:143], v[160:163], v[88:91]
    ds_read_b64_tr_b16 v[186:187], v25 offset:19200
    v_mfma_f32_16x16x32_bf16 v[92:95], v[140:143], v[164:167], v[92:95]
    ds_read_b64_tr_b16 v[188:189], v26 offset:18432
    s_waitcnt lgkmcnt(15)
    v_mfma_f32_16x16x32_bf16 v[96:99], v[144:147], v[152:155], v[96:99]
    ds_read_b64_tr_b16 v[190:191], v26 offset:19200
    v_mfma_f32_16x16x32_bf16 v[100:103], v[144:147], v[156:159], v[100:103]
    v_mfma_f32_16x16x32_bf16 v[104:107], v[144:147], v[160:163], v[104:107]
    v_mfma_f32_16x16x32_bf16 v[108:111], v[144:147], v[164:167], v[108:111]
    v_mfma_f32_16x16x32_bf16 v[112:115], v[148:151], v[152:155], v[112:115]
    v_mfma_f32_16x16x32_bf16 v[116:119], v[148:151], v[156:159], v[116:119]
    v_mfma_f32_16x16x32_bf16 v[120:123], v[148:151], v[160:163], v[120:123]
    v_mfma_f32_16x16x32_bf16 v[124:127], v[148:151], v[164:167], v[124:127]
    s_waitcnt lgkmcnt(0)
    s_barrier
    v_mov_b32 v22, v16
    v_mov_b32 v23, v17
    v_mov_b32 v24, v18
    v_mov_b32 v25, v19
    v_mov_b32 v26, v20
    v_mfma_f32_16x16x32_bf16 v[32:35], v[168:171], v[192:195], v[32:35]
    v_mfma_f32_16x16x32_bf16 v[36:39], v[168:171], v[196:199], v[36:39]
    ds_read_b128 v[152:155], v22 offset:0
    v_mfma_f32_16x16x32_bf16 v[40:43], v[168:171], v[200:203], v[40:43]
    ds_read_b128 v[156:159], v22 offset:2048
    v_mfma_f32_16x16x32_bf16 v[44:47], v[168:171], v[204:207], v[44:47]
    ds_read_b128 v[160:163], v22 offset:4096
    v_mfma_f32_16x16x32_bf16 v[48:51], v[172:175], v[192:195], v[48:51]
    ds_read_b128 v[164:167], v22 offset:6144
    v_mfma_f32_16x16x32_bf16 v[52:55], v[172:175], v[196:199], v[52:55]
    ds_read_b64_tr_b16 v[128:129], v24 offset:0
    v_mfma_f32_16x16x32_bf16 v[56:59], v[172:175], v[200:203], v[56:59]
    ds_read_b64_tr_b16 v[130:131], v24 offset:768
    v_mfma_f32_16x16x32_bf16 v[60:63], v[172:175], v[204:207], v[60:63]
    ds_read_b64_tr_b16 v[132:133], v25 offset:0
    v_mfma_f32_16x16x32_bf16 v[64:67], v[176:179], v[192:195], v[64:67]
    ds_read_b64_tr_b16 v[134:135], v25 offset:768
    v_mfma_f32_16x16x32_bf16 v[68:71], v[176:179], v[196:199], v[68:71]
    ds_read_b64_tr_b16 v[136:137], v26 offset:0
    v_mfma_f32_16x16x32_bf16 v[72:75], v[176:179], v[200:203], v[72:75]
    ds_read_b64_tr_b16 v[138:139], v26 offset:768
    v_mfma_f32_16x16x32_bf16 v[76:79], v[176:179], v[204:207], v[76:79]
    ds_read_b64_tr_b16 v[140:141], v24 offset:12288
    v_mfma_f32_16x16x32_bf16 v[80:83], v[180:183], v[192:195], v[80:83]
    ds_read_b64_tr_b16 v[142:143], v24 offset:13056
    v_mfma_f32_16x16x32_bf16 v[84:87], v[180:183], v[196:199], v[84:87]
    ds_read_b64_tr_b16 v[144:145], v25 offset:12288
    v_mfma_f32_16x16x32_bf16 v[88:91], v[180:183], v[200:203], v[88:91]
    ds_read_b64_tr_b16 v[146:147], v25 offset:13056
    v_mfma_f32_16x16x32_bf16 v[92:95], v[180:183], v[204:207], v[92:95]
    ds_read_b64_tr_b16 v[148:149], v26 offset:12288
    v_mfma_f32_16x16x32_bf16 v[96:99], v[184:187], v[192:195], v[96:99]
    ds_read_b64_tr_b16 v[150:151], v26 offset:13056
    v_mfma_f32_16x16x32_bf16 v[100:103], v[184:187], v[196:199], v[100:103]
    v_mfma_f32_16x16x32_bf16 v[104:107], v[184:187], v[200:203], v[104:107]
    v_mfma_f32_16x16x32_bf16 v[108:111], v[184:187], v[204:207], v[108:111]
    v_mfma_f32_16x16x32_bf16 v[112:115], v[188:191], v[192:195], v[112:115]
    v_mfma_f32_16x16x32_bf16 v[116:119], v[188:191], v[196:199], v[116:119]
    v_mfma_f32_16x16x32_bf16 v[120:123], v[188:191], v[200:203], v[120:123]
    v_mfma_f32_16x16x32_bf16 v[124:127], v[188:191], v[204:207], v[124:127]
    s_waitcnt lgkmcnt(10)
    v_mfma_f32_16x16x32_bf16 v[32:35], v[128:131], v[152:155], v[32:35]
    v_mfma_f32_16x16x32_bf16 v[36:39], v[128:131], v[156:159], v[36:39]
    ds_read_b128 v[192:195], v23 offset:0
    v_mfma_f32_16x16x32_bf16 v[40:43], v[128:131], v[160:163], v[40:43]
    ds_read_b128 v[196:199], v23 offset:2048
    v_mfma_f32_16x16x32_bf16 v[44:47], v[128:131], v[164:167], v[44:47]
    ds_read_b128 v[200:203], v23 offset:4096
    s_waitcnt lgkmcnt(11)
    v_mfma_f32_16x16x32_bf16 v[48:51], v[132:135], v[152:155], v[48:51]
    ds_read_b128 v[204:207], v23 offset:6144
    v_mfma_f32_16x16x32_bf16 v[52:55], v[132:135], v[156:159], v[52:55]
    ds_read_b64_tr_b16 v[168:169], v24 offset:6144
    v_mfma_f32_16x16x32_bf16 v[56:59], v[132:135], v[160:163], v[56:59]
    ds_read_b64_tr_b16 v[170:171], v24 offset:6912
    v_mfma_f32_16x16x32_bf16 v[60:63], v[132:135], v[164:167], v[60:63]
    ds_read_b64_tr_b16 v[172:173], v25 offset:6144
    s_waitcnt lgkmcnt(13)
    v_mfma_f32_16x16x32_bf16 v[64:67], v[136:139], v[152:155], v[64:67]
    ds_read_b64_tr_b16 v[174:175], v25 offset:6912
    v_mfma_f32_16x16x32_bf16 v[68:71], v[136:139], v[156:159], v[68:71]
    ds_read_b64_tr_b16 v[176:177], v26 offset:6144
    v_mfma_f32_16x16x32_bf16 v[72:75], v[136:139], v[160:163], v[72:75]
    ds_read_b64_tr_b16 v[178:179], v26 offset:6912
    v_mfma_f32_16x16x32_bf16 v[76:79], v[136:139], v[164:167], v[76:79]
    ds_read_b64_tr_b16 v[180:181], v24 offset:18432
    s_waitcnt lgkmcnt(15)
    v_mfma_f32_16x16x32_bf16 v[80:83], v[140:143], v[152:155], v[80:83]
    ds_read_b64_tr_b16 v[182:183], v24 offset:19200
    v_mfma_f32_16x16x32_bf16 v[84:87], v[140:143], v[156:159], v[84:87]
    ds_read_b64_tr_b16 v[184:185], v25 offset:18432
    v_mfma_f32_16x16x32_bf16 v[88:91], v[140:143], v[160:163], v[88:91]
    ds_read_b64_tr_b16 v[186:187], v25 offset:19200
    v_mfma_f32_16x16x32_bf16 v[92:95], v[140:143], v[164:167], v[92:95]
    ds_read_b64_tr_b16 v[188:189], v26 offset:18432
    s_waitcnt lgkmcnt(15)
    v_mfma_f32_16x16x32_bf16 v[96:99], v[144:147], v[152:155], v[96:99]
    ds_read_b64_tr_b16 v[190:191], v26 offset:19200
    v_mfma_f32_16x16x32_bf16 v[100:103], v[144:147], v[156:159], v[100:103]
    v_mfma_f32_16x16x32_bf16 v[104:107], v[144:147], v[160:163], v[104:107]
    v_mfma_f32_16x16x32_bf16 v[108:111], v[144:147], v[164:167], v[108:111]
    v_mfma_f32_16x16x32_bf16 v[112:115], v[148:151], v[152:155], v[112:115]
    v_mfma_f32_16x16x32_bf16 v[116:119], v[148:151], v[156:159], v[116:119]
    v_mfma_f32_16x16x32_bf16 v[120:123], v[148:151], v[160:163], v[120:123]
    v_mfma_f32_16x16x32_bf16 v[124:127], v[148:151], v[164:167], v[124:127]
    s_waitcnt lgkmcnt(0)
    v_mov_b32 v208, 143920
    v_mov_b32 v209, 1
    s_mov_b64 exec, 1
    ds_add_u32 v208, v209
    s_mov_b64 exec, -1
    v_mov_b32 v208, 143916
    s_mov_b32 s55, 200000
G_S7W:
    ds_read_b32 v209, v208
    s_waitcnt lgkmcnt(0)
    v_readfirstlane_b32 s54, v209
    s_cmp_ge_u32 s54, 4
    s_cbranch_scc1 G_S7OK
    s_sub_u32 s55, s55, 1
    s_cmp_lg_u32 s55, 0
    s_cbranch_scc1 G_S7W
G_S7OK:
    v_add_u32 v22, 40960, v16
    v_add_u32 v23, 40960, v17
    v_add_u32 v24, 40960, v18
    v_add_u32 v25, 40960, v19
    v_add_u32 v26, 40960, v20
    v_mfma_f32_16x16x32_bf16 v[32:35], v[168:171], v[192:195], v[32:35]
    v_mfma_f32_16x16x32_bf16 v[36:39], v[168:171], v[196:199], v[36:39]
    ds_read_b128 v[152:155], v22 offset:0
    v_mfma_f32_16x16x32_bf16 v[40:43], v[168:171], v[200:203], v[40:43]
    ds_read_b128 v[156:159], v22 offset:2048
    v_mfma_f32_16x16x32_bf16 v[44:47], v[168:171], v[204:207], v[44:47]
    ds_read_b128 v[160:163], v22 offset:4096
    v_mfma_f32_16x16x32_bf16 v[48:51], v[172:175], v[192:195], v[48:51]
    ds_read_b128 v[164:167], v22 offset:6144
    v_mfma_f32_16x16x32_bf16 v[52:55], v[172:175], v[196:199], v[52:55]
    ds_read_b64_tr_b16 v[128:129], v24 offset:0
    v_mfma_f32_16x16x32_bf16 v[56:59], v[172:175], v[200:203], v[56:59]
    ds_read_b64_tr_b16 v[130:131], v24 offset:768
    v_mfma_f32_16x16x32_bf16 v[60:63], v[172:175], v[204:207], v[60:63]
    ds_read_b64_tr_b16 v[132:133], v25 offset:0
    v_mfma_f32_16x16x32_bf16 v[64:67], v[176:179], v[192:195], v[64:67]
    ds_read_b64_tr_b16 v[134:135], v25 offset:768
    v_mfma_f32_16x16x32_bf16 v[68:71], v[176:179], v[196:199], v[68:71]
    ds_read_b64_tr_b16 v[136:137], v26 offset:0
    v_mfma_f32_16x16x32_bf16 v[72:75], v[176:179], v[200:203], v[72:75]
    ds_read_b64_tr_b16 v[138:139], v26 offset:768
    v_mfma_f32_16x16x32_bf16 v[76:79], v[176:179], v[204:207], v[76:79]
    ds_read_b64_tr_b16 v[140:141], v24 offset:12288
    v_mfma_f32_16x16x32_bf16 v[80:83], v[180:183], v[192:195], v[80:83]
    ds_read_b64_tr_b16 v[142:143], v24 offset:13056
    v_mfma_f32_16x16x32_bf16 v[84:87], v[180:183], v[196:199], v[84:87]
    ds_read_b64_tr_b16 v[144:145], v25 offset:12288
    v_mfma_f32_16x16x32_bf16 v[88:91], v[180:183], v[200:203], v[88:91]
    ds_read_b64_tr_b16 v[146:147], v25 offset:13056
    v_mfma_f32_16x16x32_bf16 v[92:95], v[180:183], v[204:207], v[92:95]
    ds_read_b64_tr_b16 v[148:149], v26 offset:12288
    v_mfma_f32_16x16x32_bf16 v[96:99], v[184:187], v[192:195], v[96:99]
    ds_read_b64_tr_b16 v[150:151], v26 offset:13056
    v_mfma_f32_16x16x32_bf16 v[100:103], v[184:187], v[196:199], v[100:103]
    v_mfma_f32_16x16x32_bf16 v[104:107], v[184:187], v[200:203], v[104:107]
    v_mfma_f32_16x16x32_bf16 v[108:111], v[184:187], v[204:207], v[108:111]
    v_mfma_f32_16x16x32_bf16 v[112:115], v[188:191], v[192:195], v[112:115]
    v_mfma_f32_16x16x32_bf16 v[116:119], v[188:191], v[196:199], v[116:119]
    v_mfma_f32_16x16x32_bf16 v[120:123], v[188:191], v[200:203], v[120:123]
    v_mfma_f32_16x16x32_bf16 v[124:127], v[188:191], v[204:207], v[124:127]
    s_waitcnt lgkmcnt(10)
    v_mfma_f32_16x16x32_bf16 v[32:35], v[128:131], v[152:155], v[32:35]
    v_mfma_f32_16x16x32_bf16 v[36:39], v[128:131], v[156:159], v[36:39]
    ds_read_b128 v[192:195], v23 offset:0
    v_mfma_f32_16x16x32_bf16 v[40:43], v[128:131], v[160:163], v[40:43]
    ds_read_b128 v[196:199], v23 offset:2048
    v_mfma_f32_16x16x32_bf16 v[44:47], v[128:131], v[164:167], v[44:47]
    ds_read_b128 v[200:203], v23 offset:4096
    s_waitcnt lgkmcnt(11)
    v_mfma_f32_16x16x32_bf16 v[48:51], v[132:135], v[152:155], v[48:51]
    ds_read_b128 v[204:207], v23 offset:6144
    v_mfma_f32_16x16x32_bf16 v[52:55], v[132:135], v[156:159], v[52:55]
    ds_read_b64_tr_b16 v[168:169], v24 offset:6144
    v_mfma_f32_16x16x32_bf16 v[56:59], v[132:135], v[160:163], v[56:59]
    ds_read_b64_tr_b16 v[170:171], v24 offset:6912
    v_mfma_f32_16x16x32_bf16 v[60:63], v[132:135], v[164:167], v[60:63]
    ds_read_b64_tr_b16 v[172:173], v25 offset:6144
    s_waitcnt lgkmcnt(13)
    v_mfma_f32_16x16x32_bf16 v[64:67], v[136:139], v[152:155], v[64:67]
    ds_read_b64_tr_b16 v[174:175], v25 offset:6912
    v_mfma_f32_16x16x32_bf16 v[68:71], v[136:139], v[156:159], v[68:71]
    ds_read_b64_tr_b16 v[176:177], v26 offset:6144
    v_mfma_f32_16x16x32_bf16 v[72:75], v[136:139], v[160:163], v[72:75]
    ds_read_b64_tr_b16 v[178:179], v26 offset:6912
    v_mfma_f32_16x16x32_bf16 v[76:79], v[136:139], v[164:167], v[76:79]
    ds_read_b64_tr_b16 v[180:181], v24 offset:18432
    s_waitcnt lgkmcnt(15)
    v_mfma_f32_16x16x32_bf16 v[80:83], v[140:143], v[152:155], v[80:83]
    ds_read_b64_tr_b16 v[182:183], v24 offset:19200
    v_mfma_f32_16x16x32_bf16 v[84:87], v[140:143], v[156:159], v[84:87]
    ds_read_b64_tr_b16 v[184:185], v25 offset:18432
    v_mfma_f32_16x16x32_bf16 v[88:91], v[140:143], v[160:163], v[88:91]
    ds_read_b64_tr_b16 v[186:187], v25 offset:19200
    v_mfma_f32_16x16x32_bf16 v[92:95], v[140:143], v[164:167], v[92:95]
    ds_read_b64_tr_b16 v[188:189], v26 offset:18432
    s_waitcnt lgkmcnt(15)
    v_mfma_f32_16x16x32_bf16 v[96:99], v[144:147], v[152:155], v[96:99]
    ds_read_b64_tr_b16 v[190:191], v26 offset:19200
    v_mfma_f32_16x16x32_bf16 v[100:103], v[144:147], v[156:159], v[100:103]
    v_mfma_f32_16x16x32_bf16 v[104:107], v[144:147], v[160:163], v[104:107]
    v_mfma_f32_16x16x32_bf16 v[108:111], v[144:147], v[164:167], v[108:111]
    v_mfma_f32_16x16x32_bf16 v[112:115], v[148:151], v[152:155], v[112:115]
    v_mfma_f32_16x16x32_bf16 v[116:119], v[148:151], v[156:159], v[116:119]
    v_mfma_f32_16x16x32_bf16 v[120:123], v[148:151], v[160:163], v[120:123]
    v_mfma_f32_16x16x32_bf16 v[124:127], v[148:151], v[164:167], v[124:127]
    s_waitcnt lgkmcnt(0)
    v_mov_b32 v208, 143924
    v_mov_b32 v209, 1
    s_mov_b64 exec, 1
    ds_add_u32 v208, v209
    s_mov_b64 exec, -1
    s_waitcnt lgkmcnt(0)
    s_setprio 3
    v_mfma_f32_16x16x32_bf16 v[32:35], v[168:171], v[192:195], v[32:35]
    v_mfma_f32_16x16x32_bf16 v[80:83], v[180:183], v[192:195], v[80:83]
    v_mfma_f32_16x16x32_bf16 v[36:39], v[168:171], v[196:199], v[36:39]
    v_mfma_f32_16x16x32_bf16 v[84:87], v[180:183], v[196:199], v[84:87]
    v_mfma_f32_16x16x32_bf16 v[40:43], v[168:171], v[200:203], v[40:43]
    v_mfma_f32_16x16x32_bf16 v[88:91], v[180:183], v[200:203], v[88:91]
    v_mfma_f32_16x16x32_bf16 v[44:47], v[168:171], v[204:207], v[44:47]
    v_mfma_f32_16x16x32_bf16 v[92:95], v[180:183], v[204:207], v[92:95]
    v_mov_b32 v5, 143908
    s_mov_b32 s55, 200000
G_RCW:
    ds_read_b32 v6, v5
    s_waitcnt lgkmcnt(0)
    v_readfirstlane_b32 s54, v6
    s_cmp_lg_u32 s54, 0
    s_cbranch_scc1 G_RCOK
    s_sleep 2
    s_sub_u32 s55, s55, 1
    s_cmp_lg_u32 s55, 0
    s_cbranch_scc1 G_RCW
G_RCOK:
    v_mov_b32 v5, 143872
    ds_read_b32 v6, v5
    v_and_b32 v7, 15, v1
    v_lshlrev_b32 v7, 4, v7
    s_lshl_b32 s55, s70, 10
    s_add_u32 s55, s55, 141824
    v_add_u32 v7, s55, v7
    ds_read_b128 v[216:219], v7 offset:0
    ds_read_b128 v[220:223], v7 offset:256
    ds_read_b128 v[224:227], v7 offset:512
    ds_read_b128 v[228:231], v7 offset:768
    v_lshrrev_b32 v8, 4, v1
    v_lshlrev_b32 v8, 4, v8
    s_mul_i32 s54, s71, 192
    s_add_u32 s54, s54, 140288
    v_add_u32 v8, s54, v8
    ds_read_b128 v[232:235], v8 offset:0
    ds_read_b128 v[236:239], v8 offset:64
    ds_read_b128 v[240:243], v8 offset:128
    ds_read_b128 v[244:247], v8 offset:384
    ds_read_b128 v[248:251], v8 offset:448
    ds_read_b128 v[252:255], v8 offset:512
    s_waitcnt lgkmcnt(0)
    v_readfirstlane_b32 s49, v6
    v_mfma_f32_16x16x32_bf16 v[48:51], v[172:175], v[192:195], v[48:51]
    v_mfma_f32_16x16x32_bf16 v[96:99], v[184:187], v[192:195], v[96:99]
    v_pk_fma_f32 v[32:33], v[232:233], v[216:217], v[32:33] op_sel:[0,0,0] op_sel_hi:[1,0,1] neg_lo:[0,1,0] neg_hi:[0,1,0]
    v_pk_fma_f32 v[34:35], v[234:235], v[216:217], v[34:35] op_sel:[0,0,0] op_sel_hi:[1,0,1] neg_lo:[0,1,0] neg_hi:[0,1,0]
    v_pk_mul_f32 v[32:33], v[32:33], v[216:217] op_sel:[0,1] op_sel_hi:[1,1]
    v_pk_mul_f32 v[34:35], v[34:35], v[216:217] op_sel:[0,1] op_sel_hi:[1,1]
    v_exp_f32 v32, v32
    v_exp_f32 v33, v33
    v_pk_fma_f32 v[80:81], v[244:245], v[216:217], v[80:81] op_sel:[0,0,0] op_sel_hi:[1,0,1] neg_lo:[0,1,0] neg_hi:[0,1,0]
    v_exp_f32 v34, v34
    v_exp_f32 v35, v35
    v_pk_fma_f32 v[82:83], v[246:247], v[216:217], v[82:83] op_sel:[0,0,0] op_sel_hi:[1,0,1] neg_lo:[0,1,0] neg_hi:[0,1,0]
    v_pk_fma_f32 v[32:33], v[32:33], v[218:219], v[218:219] op_sel:[0,0,0] op_sel_hi:[1,0,0]
    v_pk_fma_f32 v[34:35], v[34:35], v[218:219], v[218:219] op_sel:[0,0,0] op_sel_hi:[1,0,0]
    v_rcp_f32 v32, v32
    v_rcp_f32 v33, v33
    v_rcp_f32 v34, v34
    v_rcp_f32 v35, v35
    v_pk_mul_f32 v[32:33], v[32:33], v[80:81]
    v_pk_mul_f32 v[34:35], v[34:35], v[82:83]
    v_cvt_pk_bf16_f32 v128, v32, v33
    v_cvt_pk_bf16_f32 v129, v34, v35
    v_mfma_f32_16x16x32_bf16 v[52:55], v[172:175], v[196:199], v[52:55]
    v_mfma_f32_16x16x32_bf16 v[100:103], v[184:187], v[196:199], v[100:103]
    v_pk_fma_f32 v[36:37], v[232:233], v[220:221], v[36:37] op_sel:[0,0,0] op_sel_hi:[1,0,1] neg_lo:[0,1,0] neg_hi:[0,1,0]
    v_pk_fma_f32 v[38:39], v[234:235], v[220:221], v[38:39] op_sel:[0,0,0] op_sel_hi:[1,0,1] neg_lo:[0,1,0] neg_hi:[0,1,0]
    v_pk_mul_f32 v[36:37], v[36:37], v[220:221] op_sel:[0,1] op_sel_hi:[1,1]
    v_pk_mul_f32 v[38:39], v[38:39], v[220:221] op_sel:[0,1] op_sel_hi:[1,1]
    v_exp_f32 v36, v36
    v_exp_f32 v37, v37
    v_pk_fma_f32 v[84:85], v[244:245], v[220:221], v[84:85] op_sel:[0,0,0] op_sel_hi:[1,0,1] neg_lo:[0,1,0] neg_hi:[0,1,0]
    v_exp_f32 v38, v38
    v_exp_f32 v39, v39
    v_pk_fma_f32 v[86:87], v[246:247], v[220:221], v[86:87] op_sel:[0,0,0] op_sel_hi:[1,0,1] neg_lo:[0,1,0] neg_hi:[0,1,0]
    v_pk_fma_f32 v[36:37], v[36:37], v[222:223], v[222:223] op_sel:[0,0,0] op_sel_hi:[1,0,0]
    v_pk_fma_f32 v[38:39], v[38:39], v[222:223], v[222:223] op_sel:[0,0,0] op_sel_hi:[1,0,0]
    v_rcp_f32 v36, v36
    v_rcp_f32 v37, v37
    v_rcp_f32 v38, v38
    v_rcp_f32 v39, v39
    v_pk_mul_f32 v[36:37], v[36:37], v[84:85]
    v_pk_mul_f32 v[38:39], v[38:39], v[86:87]
    v_cvt_pk_bf16_f32 v136, v36, v37
    v_cvt_pk_bf16_f32 v137, v38, v39
    v_mfma_f32_16x16x32_bf16 v[56:59], v[172:175], v[200:203], v[56:59]
    v_mfma_f32_16x16x32_bf16 v[104:107], v[184:187], v[200:203], v[104:107]
    v_pk_fma_f32 v[40:41], v[232:233], v[224:225], v[40:41] op_sel:[0,0,0] op_sel_hi:[1,0,1] neg_lo:[0,1,0] neg_hi:[0,1,0]
    v_pk_fma_f32 v[42:43], v[234:235], v[224:225], v[42:43] op_sel:[0,0,0] op_sel_hi:[1,0,1] neg_lo:[0,1,0] neg_hi:[0,1,0]
    v_pk_mul_f32 v[40:41], v[40:41], v[224:225] op_sel:[0,1] op_sel_hi:[1,1]
    v_pk_mul_f32 v[42:43], v[42:43], v[224:225] op_sel:[0,1] op_sel_hi:[1,1]
    v_exp_f32 v40, v40
    v_exp_f32 v41, v41
    v_pk_fma_f32 v[88:89], v[244:245], v[224:225], v[88:89] op_sel:[0,0,0] op_sel_hi:[1,0,1] neg_lo:[0,1,0] neg_hi:[0,1,0]
    v_exp_f32 v42, v42
    v_exp_f32 v43, v43
    v_pk_fma_f32 v[90:91], v[246:247], v[224:225], v[90:91] op_sel:[0,0,0] op_sel_hi:[1,0,1] neg_lo:[0,1,0] neg_hi:[0,1,0]
    v_pk_fma_f32 v[40:41], v[40:41], v[226:227], v[226:227] op_sel:[0,0,0] op_sel_hi:[1,0,0]
    v_pk_fma_f32 v[42:43], v[42:43], v[226:227], v[226:227] op_sel:[0,0,0] op_sel_hi:[1,0,0]
    v_rcp_f32 v40, v40
    v_rcp_f32 v41, v41
    v_rcp_f32 v42, v42
    v_rcp_f32 v43, v43
    v_pk_mul_f32 v[40:41], v[40:41], v[88:89]
    v_pk_mul_f32 v[42:43], v[42:43], v[90:91]
    v_cvt_pk_bf16_f32 v144, v40, v41
    v_cvt_pk_bf16_f32 v145, v42, v43
    v_mfma_f32_16x16x32_bf16 v[60:63], v[172:175], v[204:207], v[60:63]
    v_mfma_f32_16x16x32_bf16 v[108:111], v[184:187], v[204:207], v[108:111]
    v_pk_fma_f32 v[44:45], v[232:233], v[228:229], v[44:45] op_sel:[0,0,0] op_sel_hi:[1,0,1] neg_lo:[0,1,0] neg_hi:[0,1,0]
    v_pk_fma_f32 v[46:47], v[234:235], v[228:229], v[46:47] op_sel:[0,0,0] op_sel_hi:[1,0,1] neg_lo:[0,1,0] neg_hi:[0,1,0]
    v_pk_mul_f32 v[44:45], v[44:45], v[228:229] op_sel:[0,1] op_sel_hi:[1,1]
    v_pk_mul_f32 v[46:47], v[46:47], v[228:229] op_sel:[0,1] op_sel_hi:[1,1]
    v_exp_f32 v44, v44
    v_exp_f32 v45, v45
    v_pk_fma_f32 v[92:93], v[244:245], v[228:229], v[92:93] op_sel:[0,0,0] op_sel_hi:[1,0,1] neg_lo:[0,1,0] neg_hi:[0,1,0]
    v_exp_f32 v46, v46
    v_exp_f32 v47, v47
    v_pk_fma_f32 v[94:95], v[246:247], v[228:229], v[94:95] op_sel:[0,0,0] op_sel_hi:[1,0,1] neg_lo:[0,1,0] neg_hi:[0,1,0]
    v_pk_fma_f32 v[44:45], v[44:45], v[230:231], v[230:231] op_sel:[0,0,0] op_sel_hi:[1,0,0]
    v_pk_fma_f32 v[46:47], v[46:47], v[230:231], v[230:231] op_sel:[0,0,0] op_sel_hi:[1,0,0]
    v_rcp_f32 v44, v44
    v_rcp_f32 v45, v45
    v_rcp_f32 v46, v46
    v_rcp_f32 v47, v47
    v_pk_mul_f32 v[44:45], v[44:45], v[92:93]
    v_pk_mul_f32 v[46:47], v[46:47], v[94:95]
    v_cvt_pk_bf16_f32 v152, v44, v45
    v_cvt_pk_bf16_f32 v153, v46, v47
    s_cmp_eq_u32 s71, 0
    s_cbranch_scc1 G_NSEND
    s_lshl_b32 s54, s70, 11
    s_add_u32 s54, s54, 158816
    v_lshlrev_b32 v5, 3, v1
    v_add_u32 v5, s54, v5
    ds_write_b64 v5, v[128:129] offset:0
    ds_write_b64 v5, v[136:137] offset:512
    ds_write_b64 v5, v[144:145] offset:1024
    ds_write_b64 v5, v[152:153] offset:1536
    s_lshl_b32 s54, s70, 2
    s_add_u32 s54, s54, 143880
    v_mov_b32 v5, s54
    v_mov_b32 v6, 1
    s_waitcnt lgkmcnt(0)
    ds_write_b32 v5, v6
G_NSEND:
    v_mfma_f32_16x16x32_bf16 v[64:67], v[176:179], v[192:195], v[64:67]
    v_mfma_f32_16x16x32_bf16 v[112:115], v[188:191], v[192:195], v[112:115]
    v_pk_fma_f32 v[48:49], v[236:237], v[216:217], v[48:49] op_sel:[0,0,0] op_sel_hi:[1,0,1] neg_lo:[0,1,0] neg_hi:[0,1,0]
    v_pk_fma_f32 v[50:51], v[238:239], v[216:217], v[50:51] op_sel:[0,0,0] op_sel_hi:[1,0,1] neg_lo:[0,1,0] neg_hi:[0,1,0]
    v_pk_mul_f32 v[48:49], v[48:49], v[216:217] op_sel:[0,1] op_sel_hi:[1,1]
    v_pk_mul_f32 v[50:51], v[50:51], v[216:217] op_sel:[0,1] op_sel_hi:[1,1]
    v_exp_f32 v48, v48
    v_exp_f32 v49, v49
    v_pk_fma_f32 v[96:97], v[248:249], v[216:217], v[96:97] op_sel:[0,0,0] op_sel_hi:[1,0,1] neg_lo:[0,1,0] neg_hi:[0,1,0]
    v_exp_f32 v50, v50
    v_exp_f32 v51, v51
    v_pk_fma_f32 v[98:99], v[250:251], v[216:217], v[98:99] op_sel:[0,0,0] op_sel_hi:[1,0,1] neg_lo:[0,1,0] neg_hi:[0,1,0]
    v_pk_fma_f32 v[48:49], v[48:49], v[218:219], v[218:219] op_sel:[0,0,0] op_sel_hi:[1,0,0]
    v_pk_fma_f32 v[50:51], v[50:51], v[218:219], v[218:219] op_sel:[0,0,0] op_sel_hi:[1,0,0]
    v_rcp_f32 v48, v48
    v_rcp_f32 v49, v49
    v_rcp_f32 v50, v50
    v_rcp_f32 v51, v51
    v_pk_mul_f32 v[48:49], v[48:49], v[96:97]
    v_pk_mul_f32 v[50:51], v[50:51], v[98:99]
    v_cvt_pk_bf16_f32 v130, v48, v49
    v_cvt_pk_bf16_f32 v131, v50, v51
    v_mfma_f32_16x16x32_bf16 v[68:71], v[176:179], v[196:199], v[68:71]
    v_mfma_f32_16x16x32_bf16 v[116:119], v[188:191], v[196:199], v[116:119]
    v_pk_fma_f32 v[52:53], v[236:237], v[220:221], v[52:53] op_sel:[0,0,0] op_sel_hi:[1,0,1] neg_lo:[0,1,0] neg_hi:[0,1,0]
    v_pk_fma_f32 v[54:55], v[238:239], v[220:221], v[54:55] op_sel:[0,0,0] op_sel_hi:[1,0,1] neg_lo:[0,1,0] neg_hi:[0,1,0]
    v_pk_mul_f32 v[52:53], v[52:53], v[220:221] op_sel:[0,1] op_sel_hi:[1,1]
    v_pk_mul_f32 v[54:55], v[54:55], v[220:221] op_sel:[0,1] op_sel_hi:[1,1]
    v_exp_f32 v52, v52
    v_exp_f32 v53, v53
    v_pk_fma_f32 v[100:101], v[248:249], v[220:221], v[100:101] op_sel:[0,0,0] op_sel_hi:[1,0,1] neg_lo:[0,1,0] neg_hi:[0,1,0]
    v_exp_f32 v54, v54
    v_exp_f32 v55, v55
    v_pk_fma_f32 v[102:103], v[250:251], v[220:221], v[102:103] op_sel:[0,0,0] op_sel_hi:[1,0,1] neg_lo:[0,1,0] neg_hi:[0,1,0]
    v_pk_fma_f32 v[52:53], v[52:53], v[222:223], v[222:223] op_sel:[0,0,0] op_sel_hi:[1,0,0]
    v_pk_fma_f32 v[54:55], v[54:55], v[222:223], v[222:223] op_sel:[0,0,0] op_sel_hi:[1,0,0]
    v_rcp_f32 v52, v52
    v_rcp_f32 v53, v53
    v_rcp_f32 v54, v54
    v_rcp_f32 v55, v55
    v_pk_mul_f32 v[52:53], v[52:53], v[100:101]
    v_pk_mul_f32 v[54:55], v[54:55], v[102:103]
    v_cvt_pk_bf16_f32 v138, v52, v53
    v_cvt_pk_bf16_f32 v139, v54, v55
    v_mfma_f32_16x16x32_bf16 v[72:75], v[176:179], v[200:203], v[72:75]
    v_mfma_f32_16x16x32_bf16 v[120:123], v[188:191], v[200:203], v[120:123]
    v_pk_fma_f32 v[56:57], v[236:237], v[224:225], v[56:57] op_sel:[0,0,0] op_sel_hi:[1,0,1] neg_lo:[0,1,0] neg_hi:[0,1,0]
    v_pk_fma_f32 v[58:59], v[238:239], v[224:225], v[58:59] op_sel:[0,0,0] op_sel_hi:[1,0,1] neg_lo:[0,1,0] neg_hi:[0,1,0]
    v_pk_mul_f32 v[56:57], v[56:57], v[224:225] op_sel:[0,1] op_sel_hi:[1,1]
    v_pk_mul_f32 v[58:59], v[58:59], v[224:225] op_sel:[0,1] op_sel_hi:[1,1]
    v_exp_f32 v56, v56
    v_exp_f32 v57, v57
    v_pk_fma_f32 v[104:105], v[248:249], v[224:225], v[104:105] op_sel:[0,0,0] op_sel_hi:[1,0,1] neg_lo:[0,1,0] neg_hi:[0,1,0]
    v_exp_f32 v58, v58
    v_exp_f32 v59, v59
    v_pk_fma_f32 v[106:107], v[250:251], v[224:225], v[106:107] op_sel:[0,0,0] op_sel_hi:[1,0,1] neg_lo:[0,1,0] neg_hi:[0,1,0]
    v_pk_fma_f32 v[56:57], v[56:57], v[226:227], v[226:227] op_sel:[0,0,0] op_sel_hi:[1,0,0]
    v_pk_fma_f32 v[58:59], v[58:59], v[226:227], v[226:227] op_sel:[0,0,0] op_sel_hi:[1,0,0]
    v_rcp_f32 v56, v56
    v_rcp_f32 v57, v57
    v_rcp_f32 v58, v58
    v_rcp_f32 v59, v59
    v_pk_mul_f32 v[56:57], v[56:57], v[104:105]
    v_pk_mul_f32 v[58:59], v[58:59], v[106:107]
    v_cvt_pk_bf16_f32 v146, v56, v57
    v_cvt_pk_bf16_f32 v147, v58, v59
    v_mfma_f32_16x16x32_bf16 v[76:79], v[176:179], v[204:207], v[76:79]
    v_mfma_f32_16x16x32_bf16 v[124:127], v[188:191], v[204:207], v[124:127]
    v_pk_fma_f32 v[60:61], v[236:237], v[228:229], v[60:61] op_sel:[0,0,0] op_sel_hi:[1,0,1] neg_lo:[0,1,0] neg_hi:[0,1,0]
    v_pk_fma_f32 v[62:63], v[238:239], v[228:229], v[62:63] op_sel:[0,0,0] op_sel_hi:[1,0,1] neg_lo:[0,1,0] neg_hi:[0,1,0]
    v_pk_mul_f32 v[60:61], v[60:61], v[228:229] op_sel:[0,1] op_sel_hi:[1,1]
    v_pk_mul_f32 v[62:63], v[62:63], v[228:229] op_sel:[0,1] op_sel_hi:[1,1]
    v_exp_f32 v60, v60
    v_exp_f32 v61, v61
    v_pk_fma_f32 v[108:109], v[248:249], v[228:229], v[108:109] op_sel:[0,0,0] op_sel_hi:[1,0,1] neg_lo:[0,1,0] neg_hi:[0,1,0]
    v_exp_f32 v62, v62
    v_exp_f32 v63, v63
    v_pk_fma_f32 v[110:111], v[250:251], v[228:229], v[110:111] op_sel:[0,0,0] op_sel_hi:[1,0,1] neg_lo:[0,1,0] neg_hi:[0,1,0]
    v_pk_fma_f32 v[60:61], v[60:61], v[230:231], v[230:231] op_sel:[0,0,0] op_sel_hi:[1,0,0]
    v_pk_fma_f32 v[62:63], v[62:63], v[230:231], v[230:231] op_sel:[0,0,0] op_sel_hi:[1,0,0]
    v_rcp_f32 v60, v60
    v_rcp_f32 v61, v61
    v_rcp_f32 v62, v62
    v_rcp_f32 v63, v63
    v_pk_mul_f32 v[60:61], v[60:61], v[108:109]
    v_pk_mul_f32 v[62:63], v[62:63], v[110:111]
    v_cvt_pk_bf16_f32 v154, v60, v61
    v_cvt_pk_bf16_f32 v155, v62, v63
    v_pk_fma_f32 v[64:65], v[240:241], v[216:217], v[64:65] op_sel:[0,0,0] op_sel_hi:[1,0,1] neg_lo:[0,1,0] neg_hi:[0,1,0]
    v_pk_fma_f32 v[66:67], v[242:243], v[216:217], v[66:67] op_sel:[0,0,0] op_sel_hi:[1,0,1] neg_lo:[0,1,0] neg_hi:[0,1,0]
    v_pk_mul_f32 v[64:65], v[64:65], v[216:217] op_sel:[0,1] op_sel_hi:[1,1]
    v_pk_mul_f32 v[66:67], v[66:67], v[216:217] op_sel:[0,1] op_sel_hi:[1,1]
    v_exp_f32 v64, v64
    v_exp_f32 v65, v65
    v_pk_fma_f32 v[112:113], v[252:253], v[216:217], v[112:113] op_sel:[0,0,0] op_sel_hi:[1,0,1] neg_lo:[0,1,0] neg_hi:[0,1,0]
    v_exp_f32 v66, v66
    v_exp_f32 v67, v67
    v_pk_fma_f32 v[114:115], v[254:255], v[216:217], v[114:115] op_sel:[0,0,0] op_sel_hi:[1,0,1] neg_lo:[0,1,0] neg_hi:[0,1,0]
    v_pk_fma_f32 v[64:65], v[64:65], v[218:219], v[218:219] op_sel:[0,0,0] op_sel_hi:[1,0,0]
    v_pk_fma_f32 v[66:67], v[66:67], v[218:219], v[218:219] op_sel:[0,0,0] op_sel_hi:[1,0,0]
    v_rcp_f32 v64, v64
    v_rcp_f32 v65, v65
    v_rcp_f32 v66, v66
    v_rcp_f32 v67, v67
    v_pk_mul_f32 v[64:65], v[64:65], v[112:113]
    v_pk_mul_f32 v[66:67], v[66:67], v[114:115]
    v_cvt_pk_bf16_f32 v132, v64, v65
    v_cvt_pk_bf16_f32 v133, v66, v67
    v_pk_fma_f32 v[68:69], v[240:241], v[220:221], v[68:69] op_sel:[0,0,0] op_sel_hi:[1,0,1] neg_lo:[0,1,0] neg_hi:[0,1,0]
    v_pk_fma_f32 v[70:71], v[242:243], v[220:221], v[70:71] op_sel:[0,0,0] op_sel_hi:[1,0,1] neg_lo:[0,1,0] neg_hi:[0,1,0]
    v_pk_mul_f32 v[68:69], v[68:69], v[220:221] op_sel:[0,1] op_sel_hi:[1,1]
    v_pk_mul_f32 v[70:71], v[70:71], v[220:221] op_sel:[0,1] op_sel_hi:[1,1]
    v_exp_f32 v68, v68
    v_exp_f32 v69, v69
    v_pk_fma_f32 v[116:117], v[252:253], v[220:221], v[116:117] op_sel:[0,0,0] op_sel_hi:[1,0,1] neg_lo:[0,1,0] neg_hi:[0,1,0]
    v_exp_f32 v70, v70
    v_exp_f32 v71, v71
    v_pk_fma_f32 v[118:119], v[254:255], v[220:221], v[118:119] op_sel:[0,0,0] op_sel_hi:[1,0,1] neg_lo:[0,1,0] neg_hi:[0,1,0]
    v_pk_fma_f32 v[68:69], v[68:69], v[222:223], v[222:223] op_sel:[0,0,0] op_sel_hi:[1,0,0]
    v_pk_fma_f32 v[70:71], v[70:71], v[222:223], v[222:223] op_sel:[0,0,0] op_sel_hi:[1,0,0]
    v_rcp_f32 v68, v68
    v_rcp_f32 v69, v69
    v_rcp_f32 v70, v70
    v_rcp_f32 v71, v71
    v_pk_mul_f32 v[68:69], v[68:69], v[116:117]
    v_pk_mul_f32 v[70:71], v[70:71], v[118:119]
    v_cvt_pk_bf16_f32 v140, v68, v69
    v_cvt_pk_bf16_f32 v141, v70, v71
    v_pk_fma_f32 v[72:73], v[240:241], v[224:225], v[72:73] op_sel:[0,0,0] op_sel_hi:[1,0,1] neg_lo:[0,1,0] neg_hi:[0,1,0]
    v_pk_fma_f32 v[74:75], v[242:243], v[224:225], v[74:75] op_sel:[0,0,0] op_sel_hi:[1,0,1] neg_lo:[0,1,0] neg_hi:[0,1,0]
    v_pk_mul_f32 v[72:73], v[72:73], v[224:225] op_sel:[0,1] op_sel_hi:[1,1]
    v_pk_mul_f32 v[74:75], v[74:75], v[224:225] op_sel:[0,1] op_sel_hi:[1,1]
    v_exp_f32 v72, v72
    v_exp_f32 v73, v73
    v_pk_fma_f32 v[120:121], v[252:253], v[224:225], v[120:121] op_sel:[0,0,0] op_sel_hi:[1,0,1] neg_lo:[0,1,0] neg_hi:[0,1,0]
    v_exp_f32 v74, v74
    v_exp_f32 v75, v75
    v_pk_fma_f32 v[122:123], v[254:255], v[224:225], v[122:123] op_sel:[0,0,0] op_sel_hi:[1,0,1] neg_lo:[0,1,0] neg_hi:[0,1,0]
    v_pk_fma_f32 v[72:73], v[72:73], v[226:227], v[226:227] op_sel:[0,0,0] op_sel_hi:[1,0,0]
    v_pk_fma_f32 v[74:75], v[74:75], v[226:227], v[226:227] op_sel:[0,0,0] op_sel_hi:[1,0,0]
    v_rcp_f32 v72, v72
    v_rcp_f32 v73, v73
    v_rcp_f32 v74, v74
    v_rcp_f32 v75, v75
    v_pk_mul_f32 v[72:73], v[72:73], v[120:121]
    v_pk_mul_f32 v[74:75], v[74:75], v[122:123]
    v_cvt_pk_bf16_f32 v148, v72, v73
    v_cvt_pk_bf16_f32 v149, v74, v75
    v_pk_fma_f32 v[76:77], v[240:241], v[228:229], v[76:77] op_sel:[0,0,0] op_sel_hi:[1,0,1] neg_lo:[0,1,0] neg_hi:[0,1,0]
    v_pk_fma_f32 v[78:79], v[242:243], v[228:229], v[78:79] op_sel:[0,0,0] op_sel_hi:[1,0,1] neg_lo:[0,1,0] neg_hi:[0,1,0]
    v_pk_mul_f32 v[76:77], v[76:77], v[228:229] op_sel:[0,1] op_sel_hi:[1,1]
    v_pk_mul_f32 v[78:79], v[78:79], v[228:229] op_sel:[0,1] op_sel_hi:[1,1]
    v_exp_f32 v76, v76
    v_exp_f32 v77, v77
    v_pk_fma_f32 v[124:125], v[252:253], v[228:229], v[124:125] op_sel:[0,0,0] op_sel_hi:[1,0,1] neg_lo:[0,1,0] neg_hi:[0,1,0]
    v_exp_f32 v78, v78
    v_exp_f32 v79, v79
    v_pk_fma_f32 v[126:127], v[254:255], v[228:229], v[126:127] op_sel:[0,0,0] op_sel_hi:[1,0,1] neg_lo:[0,1,0] neg_hi:[0,1,0]
    v_pk_fma_f32 v[76:77], v[76:77], v[230:231], v[230:231] op_sel:[0,0,0] op_sel_hi:[1,0,0]
    v_pk_fma_f32 v[78:79], v[78:79], v[230:231], v[230:231] op_sel:[0,0,0] op_sel_hi:[1,0,0]
    v_rcp_f32 v76, v76
    v_rcp_f32 v77, v77
    v_rcp_f32 v78, v78
    v_rcp_f32 v79, v79
    v_pk_mul_f32 v[76:77], v[76:77], v[124:125]
    v_pk_mul_f32 v[78:79], v[78:79], v[126:127]
    v_cvt_pk_bf16_f32 v156, v76, v77
    v_cvt_pk_bf16_f32 v157, v78, v79
    s_lshl_b32 s53, s46, 3
    s_lshl_b32 s54, s70, 2
    s_add_u32 s53, s53, s54
    s_mul_i32 s53, s53, 43
    s_add_u32 s53, s53, s48
    s_lshl_b32 s53, s53, 10
    v_lshlrev_b32 v3, 4, v1
    s_cmp_eq_u32 s71, 0
    s_cbranch_scc0 G1_FH1
    s_lshl_b32 s54, s47, 3
    s_sub_u32 s54, s54, 8
    s_mul_i32 s54, s54, 21846
    s_lshr_b32 s54, s54, 16
    s_add_u32 s54, s54, 2
    s_cmp_eq_u32 s47, 0
    s_cbranch_scc1 G_ST0
    s_cmp_eq_u32 s54, s48
    s_cbranch_scc1 G_NST0
G_ST0:
    s_add_u32 s54, s53, 0
    buffer_store_dwordx4 v[128:131], v3, s[24:27], s54 offen sc1
    s_add_u32 s54, s53, 44032
    buffer_store_dwordx4 v[136:139], v3, s[24:27], s54 offen sc1
    s_add_u32 s54, s53, 88064
    buffer_store_dwordx4 v[144:147], v3, s[24:27], s54 offen sc1
    s_add_u32 s54, s53, 132096
    buffer_store_dwordx4 v[152:155], v3, s[24:27], s54 offen sc1
G_NST0:
    s_lshl_b32 s54, s70, 2
    s_add_u32 s54, s54, 143880
    v_mov_b32 v5, s54
    s_mov_b32 s55, 200000
G_HXW:
    ds_read_b32 v6, v5
    s_waitcnt lgkmcnt(0)
    v_readfirstlane_b32 s54, v6
    s_cmp_lg_u32 s54, 0
    s_cbranch_scc1 G_HXOK
    s_sleep 2
    s_sub_u32 s55, s55, 1
    s_cmp_lg_u32 s55, 0
    s_cbranch_scc1 G_HXW
G_HXOK:
    s_lshl_b32 s54, s70, 11
    s_add_u32 s54, s54, 158816
    v_lshlrev_b32 v5, 3, v1
    v_add_u32 v5, s54, v5
    ds_read_b64 v[134:135], v5 offset:0
    ds_read_b64 v[142:143], v5 offset:512
    ds_read_b64 v[150:151], v5 offset:1024
    ds_read_b64 v[158:159], v5 offset:1536
    s_waitcnt lgkmcnt(0)
    s_add_u32 s54, s53, 0
    buffer_store_dwordx4 v[132:135], v3, s[24:27], s54 offen offset:1024 sc1
    s_add_u32 s54, s53, 44032
    buffer_store_dwordx4 v[140:143], v3, s[24:27], s54 offen offset:1024 sc1
    s_add_u32 s54, s53, 88064
    buffer_store_dwordx4 v[148:151], v3, s[24:27], s54 offen offset:1024 sc1
    s_add_u32 s54, s53, 132096
    buffer_store_dwordx4 v[156:159], v3, s[24:27], s54 offen offset:1024 sc1
    s_branch G1_DONE
G1_FH1:
    s_add_u32 s54, s53, 0
    buffer_store_dwordx4 v[130:133], v3, s[24:27], s54 offen offset:2048 sc1
    s_add_u32 s54, s53, 44032
    buffer_store_dwordx4 v[138:141], v3, s[24:27], s54 offen offset:2048 sc1
    s_add_u32 s54, s53, 88064
    buffer_store_dwordx4 v[146:149], v3, s[24:27], s54 offen offset:2048 sc1
    s_add_u32 s54, s53, 132096
    buffer_store_dwordx4 v[154:157], v3, s[24:27], s54 offen offset:2048 sc1
G1_DONE:
    v_and_b32 v5, 15, v1
    v_lshrrev_b32 v6, 4, v1
    v_lshrrev_b32 v7, 2, v5
    v_lshl_add_u32 v7, v6, 2, v7
    v_bfe_u32 v8, v7, 1, 2
    v_lshlrev_b32 v8, 5, v8
    v_lshl_add_u32 v8, v7, 7, v8
    v_bfe_u32 v9, v5, 1, 1
    v_lshl_add_u32 v8, v9, 4, v8
    v_and_b32 v9, 1, v5
    v_lshl_add_u32 v8, v9, 3, v8
    v_xor_b32 v10, 0, v8
    v_xor_b32 v11, 32, v8
    v_xor_b32 v12, 64, v8
    v_xor_b32 v13, 96, v8
    s_lshl_b32 s54, s45, 2
    s_add_u32 s54, s54, 143888
    v_mov_b32 v232, s54
    s_mov_b32 s55, 200000
G_WDW:
    ds_read_b32 v233, v232
    s_waitcnt lgkmcnt(0)
    v_readfirstlane_b32 s54, v233
    s_cmp_lg_u32 s54, 0
    s_cbranch_scc1 G_WDOK
    s_sleep 2
    s_sub_u32 s55, s55, 1
    s_cmp_lg_u32 s55, 0
    s_cbranch_scc1 G_WDW
G_WDOK:
    s_add_u32 s54, s67, 81920
    v_add_u32 v232, s54, v10
    v_add_u32 v233, s54, v11
    v_add_u32 v234, s54, v12
    v_add_u32 v235, s54, v13
    ds_read_b64_tr_b16 v[80:81], v232 offset:0
    ds_read_b64_tr_b16 v[82:83], v232 offset:2048
    ds_read_b64_tr_b16 v[84:85], v233 offset:0
    ds_read_b64_tr_b16 v[86:87], v233 offset:2048
    ds_read_b64_tr_b16 v[88:89], v234 offset:0
    ds_read_b64_tr_b16 v[90:91], v234 offset:2048
    ds_read_b64_tr_b16 v[92:93], v235 offset:0
    ds_read_b64_tr_b16 v[94:95], v235 offset:2048
    s_add_u32 s54, s67, 98304
    v_add_u32 v232, s54, v10
    v_add_u32 v233, s54, v11
    v_add_u32 v234, s54, v12
    v_add_u32 v235, s54, v13
    ds_read_b64_tr_b16 v[96:97], v232 offset:0
    ds_read_b64_tr_b16 v[98:99], v232 offset:2048
    ds_read_b64_tr_b16 v[100:101], v233 offset:0
    ds_read_b64_tr_b16 v[102:103], v233 offset:2048
    ds_read_b64_tr_b16 v[104:105], v234 offset:0
    ds_read_b64_tr_b16 v[106:107], v234 offset:2048
    ds_read_b64_tr_b16 v[108:109], v235 offset:0
    ds_read_b64_tr_b16 v[110:111], v235 offset:2048
    s_add_u32 s54, s67, 0
    v_add_u32 v232, s54, v10
    v_add_u32 v233, s54, v11
    v_add_u32 v234, s54, v12
    v_add_u32 v235, s54, v13
    ds_read_b64_tr_b16 v[112:113], v232 offset:0
    ds_read_b64_tr_b16 v[114:115], v232 offset:2048
    ds_read_b64_tr_b16 v[116:117], v233 offset:0
    ds_read_b64_tr_b16 v[118:119], v233 offset:2048
    ds_read_b64_tr_b16 v[120:121], v234 offset:0
    ds_read_b64_tr_b16 v[122:123], v234 offset:2048
    ds_read_b64_tr_b16 v[124:125], v235 offset:0
    ds_read_b64_tr_b16 v[126:127], v235 offset:2048
    s_add_u32 s54, s67, 16384
    v_add_u32 v232, s54, v10
    v_add_u32 v233, s54, v11
    v_add_u32 v234, s54, v12
    v_add_u32 v235, s54, v13
    ds_read_b64_tr_b16 v[128:129], v232 offset:0
    ds_read_b64_tr_b16 v[130:131], v232 offset:2048
    ds_read_b64_tr_b16 v[132:133], v233 offset:0
    ds_read_b64_tr_b16 v[134:135], v233 offset:2048
    ds_read_b64_tr_b16 v[136:137], v234 offset:0
    ds_read_b64_tr_b16 v[138:139], v234 offset:2048
    ds_read_b64_tr_b16 v[140:141], v235 offset:0
    ds_read_b64_tr_b16 v[142:143], v235 offset:2048
    s_add_u32 s54, s68, 0
    v_add_u32 v232, s54, v10
    v_add_u32 v233, s54, v11
    v_add_u32 v234, s54, v12
    v_add_u32 v235, s54, v13
    ds_read_b64_tr_b16 v[144:145], v232 offset:0
    ds_read_b64_tr_b16 v[146:147], v232 offset:2048
    ds_read_b64_tr_b16 v[148:149], v233 offset:0
    ds_read_b64_tr_b16 v[150:151], v233 offset:2048
    ds_read_b64_tr_b16 v[152:153], v234 offset:0
    ds_read_b64_tr_b16 v[154:155], v234 offset:2048
    ds_read_b64_tr_b16 v[156:157], v235 offset:0
    ds_read_b64_tr_b16 v[158:159], v235 offset:2048
    s_waitcnt vmcnt(0)
    s_lshl_b32 s53, s46, 1
    s_add_u32 s53, s53, s70
    s_lshl_b32 s53, s53, 5
    s_lshl_b32 s54, s47, 1
    s_add_u32 s53, s53, s54
    s_add_u32 s53, s53, s71
    s_lshl_b32 s53, s53, 2
    s_add_u32 s53, s53, 4096
    v_mov_b32 v236, s49
    v_mov_b32 v237, 0
    s_mov_b64 exec, 1
    buffer_store_dword v236, v237, s[40:43], s53 offen sc1
    s_mov_b64 exec, -1
    s_setprio 1
    s_waitcnt lgkmcnt(0)
    s_add_u32 s7, s6, 5
    s_cmp_ge_u32 s7, 11
    s_cselect_b32 s3, 11, 0
    s_sub_u32 s7, s7, s3
    s_lshl_b32 s69, s7, 15
    s_add_u32 s69, s69, s72
    s_add_u32 m0, s67, 81920
    s_add_u32 s54, s69, 0
    buffer_load_dwordx4 v4, s[20:23], s54 offen lds
    s_add_u32 m0, s67, 82944
    s_add_u32 s54, s69, 8192
    buffer_load_dwordx4 v4, s[20:23], s54 offen lds
    s_add_u32 m0, s67, 83968
    s_add_u32 s54, s69, 16384
    buffer_load_dwordx4 v4, s[20:23], s54 offen lds
    s_add_u32 m0, s67, 84992
    s_add_u32 s54, s69, 24576
    buffer_load_dwordx4 v4, s[20:23], s54 offen lds
    s_add_u32 s7, s6, 6
    s_cmp_ge_u32 s7, 11
    s_cselect_b32 s3, 11, 0
    s_sub_u32 s7, s7, s3
    s_lshl_b32 s69, s7, 15
    s_add_u32 s69, s69, s72
    s_add_u32 m0, s67, 98304
    s_add_u32 s54, s69, 0
    buffer_load_dwordx4 v4, s[20:23], s54 offen lds
    s_add_u32 m0, s67, 99328
    s_add_u32 s54, s69, 8192
    buffer_load_dwordx4 v4, s[20:23], s54 offen lds
    s_add_u32 m0, s67, 100352
    s_add_u32 s54, s69, 16384
    buffer_load_dwordx4 v4, s[20:23], s54 offen lds
    s_add_u32 m0, s67, 101376
    s_add_u32 s54, s69, 24576
    buffer_load_dwordx4 v4, s[20:23], s54 offen lds
    s_waitcnt vmcnt(4)
    s_add_u32 s7, s6, 7
    s_cmp_ge_u32 s7, 11
    s_cselect_b32 s3, 11, 0
    s_sub_u32 s7, s7, s3
    s_lshl_b32 s69, s7, 15
    s_add_u32 s69, s69, s72
    s_add_u32 m0, s67, 0
    s_add_u32 s54, s69, 0
    buffer_load_dwordx4 v4, s[20:23], s54 offen lds
    s_add_u32 m0, s67, 1024
    s_add_u32 s54, s69, 8192
    buffer_load_dwordx4 v4, s[20:23], s54 offen lds
    s_add_u32 m0, s67, 2048
    s_add_u32 s54, s69, 16384
    buffer_load_dwordx4 v4, s[20:23], s54 offen lds
    s_add_u32 m0, s67, 3072
    s_add_u32 s54, s69, 24576
    buffer_load_dwordx4 v4, s[20:23], s54 offen lds
    s_add_u32 s7, s6, 8
    s_cmp_ge_u32 s7, 11
    s_cselect_b32 s3, 11, 0
    s_sub_u32 s7, s7, s3
    s_lshl_b32 s69, s7, 15
    s_add_u32 s69, s69, s72
    s_add_u32 m0, s67, 16384
    s_add_u32 s54, s69, 0
    buffer_load_dwordx4 v4, s[20:23], s54 offen lds
    s_add_u32 m0, s67, 17408
    s_add_u32 s54, s69, 8192
    buffer_load_dwordx4 v4, s[20:23], s54 offen lds
    s_add_u32 m0, s67, 18432
    s_add_u32 s54, s69, 16384
    buffer_load_dwordx4 v4, s[20:23], s54 offen lds
    s_add_u32 m0, s67, 19456
    s_add_u32 s54, s69, 24576
    buffer_load_dwordx4 v4, s[20:23], s54 offen lds
    s_waitcnt vmcnt(4)
    s_add_u32 s7, s6, 9
    s_cmp_ge_u32 s7, 11
    s_cselect_b32 s3, 11, 0
    s_sub_u32 s7, s7, s3
    s_lshl_b32 s69, s7, 15
    s_add_u32 s69, s69, s72
    s_add_u32 m0, s68, 0
    s_add_u32 s54, s69, 0
    buffer_load_dwordx4 v4, s[20:23], s54 offen lds
    s_add_u32 m0, s68, 1024
    s_add_u32 s54, s69, 8192
    buffer_load_dwordx4 v4, s[20:23], s54 offen lds
    s_add_u32 m0, s68, 2048
    s_add_u32 s54, s69, 16384
    buffer_load_dwordx4 v4, s[20:23], s54 offen lds
    s_add_u32 m0, s68, 3072
    s_add_u32 s54, s69, 24576
    buffer_load_dwordx4 v4, s[20:23], s54 offen lds
    s_lshl_b32 s53, s51, 16
    s_lshl_b32 s54, s45, 14
    s_add_u32 s53, s53, s54
    s_lshl_b32 s54, s52, 7
    s_add_u32 s75, s53, s54
    v_lshrrev_b32 v15, 2, v1
    v_lshlrev_b32 v15, 10, v15
    v_and_b32 v9, 3, v1
    v_lshl_add_u32 v15, v9, 5, v15
    buffer_load_dwordx4 v[224:227], v15, s[8:11], s75 offen
    buffer_load_dwordx4 v[228:231], v15, s[8:11], s75 offen offset:16
    s_add_u32 s7, s6, 0
    s_cmp_ge_u32 s7, 11
    s_cselect_b32 s3, 11, 0
    s_sub_u32 s7, s7, s3
    s_lshl_b32 s3, s7, 10
    s_add_u32 s3, s3, s74
    s_mul_i32 s55, s45, 11
    s_add_u32 s55, s55, s7
    s_cmp_ge_u32 s55, 43
    s_cselect_b32 s56, 5636096, s3
    s_add_u32 s7, s6, 1
    s_cmp_ge_u32 s7, 11
    s_cselect_b32 s3, 11, 0
    s_sub_u32 s7, s7, s3
    s_lshl_b32 s3, s7, 10
    s_add_u32 s3, s3, s74
    s_mul_i32 s55, s45, 11
    s_add_u32 s55, s55, s7
    s_cmp_ge_u32 s55, 43
    s_cselect_b32 s57, 5636096, s3
    s_add_u32 s7, s6, 2
    s_cmp_ge_u32 s7, 11
    s_cselect_b32 s3, 11, 0
    s_sub_u32 s7, s7, s3
    s_lshl_b32 s3, s7, 10
    s_add_u32 s3, s3, s74
    s_mul_i32 s55, s45, 11
    s_add_u32 s55, s55, s7
    s_cmp_ge_u32 s55, 43
    s_cselect_b32 s58, 5636096, s3
    s_add_u32 s7, s6, 3
    s_cmp_ge_u32 s7, 11
    s_cselect_b32 s3, 11, 0
    s_sub_u32 s7, s7, s3
    s_lshl_b32 s3, s7, 10
    s_add_u32 s3, s3, s74
    s_mul_i32 s55, s45, 11
    s_add_u32 s55, s55, s7
    s_cmp_ge_u32 s55, 43
    s_cselect_b32 s59, 5636096, s3
    s_add_u32 s7, s6, 4
    s_cmp_ge_u32 s7, 11
    s_cselect_b32 s3, 11, 0
    s_sub_u32 s7, s7, s3
    s_lshl_b32 s3, s7, 10
    s_add_u32 s3, s3, s74
    s_mul_i32 s55, s45, 11
    s_add_u32 s55, s55, s7
    s_cmp_ge_u32 s55, 43
    s_cselect_b32 s60, 5636096, s3
    s_add_u32 s7, s6, 5
    s_cmp_ge_u32 s7, 11
    s_cselect_b32 s3, 11, 0
    s_sub_u32 s7, s7, s3
    s_lshl_b32 s3, s7, 10
    s_add_u32 s3, s3, s74
    s_mul_i32 s55, s45, 11
    s_add_u32 s55, s55, s7
    s_cmp_ge_u32 s55, 43
    s_cselect_b32 s61, 5636096, s3
    s_add_u32 s7, s6, 6
    s_cmp_ge_u32 s7, 11
    s_cselect_b32 s3, 11, 0
    s_sub_u32 s7, s7, s3
    s_lshl_b32 s3, s7, 10
    s_add_u32 s3, s3, s74
    s_mul_i32 s55, s45, 11
    s_add_u32 s55, s55, s7
    s_cmp_ge_u32 s55, 43
    s_cselect_b32 s62, 5636096, s3
    s_add_u32 s7, s6, 7
    s_cmp_ge_u32 s7, 11
    s_cselect_b32 s3, 11, 0
    s_sub_u32 s7, s7, s3
    s_lshl_b32 s3, s7, 10
    s_add_u32 s3, s3, s74
    s_mul_i32 s55, s45, 11
    s_add_u32 s55, s55, s7
    s_cmp_ge_u32 s55, 43
    s_cselect_b32 s63, 5636096, s3
    s_add_u32 s7, s6, 8
    s_cmp_ge_u32 s7, 11
    s_cselect_b32 s3, 11, 0
    s_sub_u32 s7, s7, s3
    s_lshl_b32 s3, s7, 10
    s_add_u32 s3, s3, s74
    s_mul_i32 s55, s45, 11
    s_add_u32 s55, s55, s7
    s_cmp_ge_u32 s55, 43
    s_cselect_b32 s64, 5636096, s3
    s_add_u32 s7, s6, 9
    s_cmp_ge_u32 s7, 11
    s_cselect_b32 s3, 11, 0
    s_sub_u32 s7, s7, s3
    s_lshl_b32 s3, s7, 10
    s_add_u32 s3, s3, s74
    s_mul_i32 s55, s45, 11
    s_add_u32 s55, s55, s7
    s_cmp_ge_u32 s55, 43
    s_cselect_b32 s65, 5636096, s3
    s_add_u32 s7, s6, 10
    s_cmp_ge_u32 s7, 11
    s_cselect_b32 s3, 11, 0
    s_sub_u32 s7, s7, s3
    s_lshl_b32 s3, s7, 10
    s_add_u32 s3, s3, s74
    s_mul_i32 s55, s45, 11
    s_add_u32 s55, s55, s7
    s_cmp_ge_u32 s55, 43
    s_cselect_b32 s66, 5636096, s3
    s_add_u32 s53, s45, 0
    s_and_b32 s53, s53, 3
    s_mul_i32 s53, s53, 44032
    v_add_u32 v244, s53, v3
    s_add_u32 s53, s45, 1
    s_and_b32 s53, s53, 3
    s_mul_i32 s53, s53, 44032
    v_add_u32 v245, s53, v3
    s_add_u32 s53, s45, 2
    s_and_b32 s53, s53, 3
    s_mul_i32 s53, s53, 44032
    v_add_u32 v246, s53, v3
    s_add_u32 s53, s45, 3
    s_and_b32 s53, s53, 3
    s_mul_i32 s53, s53, 44032
    v_add_u32 v247, s53, v3
    v_and_b32 v14, 31, v1
    v_lshlrev_b32 v14, 2, v14
    s_lshl_b32 s55, s51, 7
    s_add_u32 s55, s55, 4096
    s_mov_b32 s53, 200000
POLL1:
    buffer_load_dword v232, v14, s[40:43], s55 offen sc1
    s_waitcnt vmcnt(0)
    v_cmp_eq_u32 vcc, s49, v232
    s_cmp_eq_u64 vcc, -1
    s_cbranch_scc1 POLL1_OK
    s_sleep 1
    s_sub_u32 s53, s53, 1
    s_cmp_lg_u32 s53, 0
    s_cbranch_scc1 POLL1
    v_mov_b32 v232, 2
    v_mov_b32 v233, 0
    global_store_dword v233, v232, s[80:81] offset:4
POLL1_OK:
    buffer_load_dwordx4 v[160:163], v244, s[24:27], s56 offen sc1
    buffer_load_dwordx4 v[164:167], v245, s[24:27], s56 offen sc1
    buffer_load_dwordx4 v[168:171], v246, s[24:27], s56 offen sc1
    buffer_load_dwordx4 v[172:175], v247, s[24:27], s56 offen sc1
    buffer_load_dwordx4 v[176:179], v244, s[24:27], s57 offen sc1
    buffer_load_dwordx4 v[180:183], v245, s[24:27], s57 offen sc1
    buffer_load_dwordx4 v[184:187], v246, s[24:27], s57 offen sc1
    buffer_load_dwordx4 v[188:191], v247, s[24:27], s57 offen sc1
    buffer_load_dwordx4 v[192:195], v244, s[24:27], s58 offen sc1
    buffer_load_dwordx4 v[196:199], v245, s[24:27], s58 offen sc1
    buffer_load_dwordx4 v[200:203], v246, s[24:27], s58 offen sc1
    buffer_load_dwordx4 v[204:207], v247, s[24:27], s58 offen sc1
    buffer_load_dwordx4 v[208:211], v244, s[24:27], s59 offen sc1
    buffer_load_dwordx4 v[212:215], v245, s[24:27], s59 offen sc1
    buffer_load_dwordx4 v[216:219], v246, s[24:27], s59 offen sc1
    buffer_load_dwordx4 v[220:223], v247, s[24:27], s59 offen sc1
    s_mul_i32 s79, s45, 2176
    s_add_u32 s79, s79, 131584
    v_lshrrev_b32 v8, 2, v1
    v_mul_u32_u24 v8, 128, v8
    v_and_b32 v9, 3, v1
    v_lshl_add_u32 v8, v9, 5, v8
    v_add_u32 v8, s79, v8
    ds_write_b128 v8, v[224:227]
    ds_write_b128 v8, v[228:231] offset:16
    v_lshrrev_b32 v8, 2, v5
    v_lshl_add_u32 v8, v6, 2, v8
    v_mul_u32_u24 v8, 128, v8
    v_and_b32 v9, 3, v5
    v_lshl_add_u32 v8, v9, 3, v8
    v_add_u32 v8, s79, v8
    s_waitcnt lgkmcnt(0)
    ds_read_b64_tr_b16 v[224:225], v8 offset:0
    ds_read_b64_tr_b16 v[226:227], v8 offset:32
    ds_read_b64_tr_b16 v[228:229], v8 offset:64
    ds_read_b64_tr_b16 v[230:231], v8 offset:96
    s_waitcnt lgkmcnt(0)
    s_lshl_b32 s76, s52, 9
    s_add_u32 s76, s76, 8192
    v_lshlrev_b32 v14, 3, v1
    s_lshl_b32 s53, s52, 18
    s_lshl_b32 s54, s51, 7
    s_add_u32 s53, s53, s54
    s_lshl_b32 s54, s45, 5
    s_add_u32 s77, s53, s54
    v_lshlrev_b32 v7, 12, v5
    v_lshl_add_u32 v7, v6, 3, v7
    s_mov_b32 s78, 0
    s_waitcnt vmcnt(12)
    v_mfma_f32_16x16x32_bf16 v[16:19], v[160:163], v[80:83], 0
    v_mfma_f32_16x16x32_bf16 v[20:23], v[160:163], v[84:87], 0
    v_mfma_f32_16x16x32_bf16 v[24:27], v[160:163], v[88:91], 0
    v_mfma_f32_16x16x32_bf16 v[28:31], v[160:163], v[92:95], 0
    v_mfma_f32_16x16x32_bf16 v[32:35], v[164:167], v[80:83], 0
    v_mfma_f32_16x16x32_bf16 v[36:39], v[164:167], v[84:87], 0
    v_mfma_f32_16x16x32_bf16 v[40:43], v[164:167], v[88:91], 0
    v_mfma_f32_16x16x32_bf16 v[44:47], v[164:167], v[92:95], 0
    v_mfma_f32_16x16x32_bf16 v[48:51], v[168:171], v[80:83], 0
    v_mfma_f32_16x16x32_bf16 v[52:55], v[168:171], v[84:87], 0
    v_mfma_f32_16x16x32_bf16 v[56:59], v[168:171], v[88:91], 0
    v_mfma_f32_16x16x32_bf16 v[60:63], v[168:171], v[92:95], 0
    v_mfma_f32_16x16x32_bf16 v[64:67], v[172:175], v[80:83], 0
    v_mfma_f32_16x16x32_bf16 v[68:71], v[172:175], v[84:87], 0
    v_mfma_f32_16x16x32_bf16 v[72:75], v[172:175], v[88:91], 0
    v_mfma_f32_16x16x32_bf16 v[76:79], v[172:175], v[92:95], 0
    s_waitcnt vmcnt(8)
    v_mfma_f32_16x16x32_bf16 v[16:19], v[176:179], v[96:99], v[16:19]
    s_add_u32 s54, s67, 81920
    v_add_u32 v232, s54, v10
    v_mfma_f32_16x16x32_bf16 v[20:23], v[176:179], v[100:103], v[20:23]
    v_add_u32 v233, s54, v11
    v_add_u32 v234, s54, v12
    v_add_u32 v235, s54, v13
    v_mfma_f32_16x16x32_bf16 v[24:27], v[176:179], v[104:107], v[24:27]
    ds_read_b64_tr_b16 v[80:81], v232 offset:0
    ds_read_b64_tr_b16 v[82:83], v232 offset:2048
    ds_read_b64_tr_b16 v[84:85], v233 offset:0
    v_mfma_f32_16x16x32_bf16 v[28:31], v[176:179], v[108:111], v[28:31]
    ds_read_b64_tr_b16 v[86:87], v233 offset:2048
    ds_read_b64_tr_b16 v[88:89], v234 offset:0
    ds_read_b64_tr_b16 v[90:91], v234 offset:2048
    v_mfma_f32_16x16x32_bf16 v[32:35], v[180:183], v[96:99], v[32:35]
    ds_read_b64_tr_b16 v[92:93], v235 offset:0
    ds_read_b64_tr_b16 v[94:95], v235 offset:2048
    buffer_load_dwordx4 v[160:163], v244, s[24:27], s60 offen sc1
    v_mfma_f32_16x16x32_bf16 v[36:39], v[180:183], v[100:103], v[36:39]
    buffer_load_dwordx4 v[164:167], v245, s[24:27], s60 offen sc1
    buffer_load_dwordx4 v[168:171], v246, s[24:27], s60 offen sc1
    buffer_load_dwordx4 v[172:175], v247, s[24:27], s60 offen sc1
    v_mfma_f32_16x16x32_bf16 v[40:43], v[180:183], v[104:107], v[40:43]
    v_mfma_f32_16x16x32_bf16 v[44:47], v[180:183], v[108:111], v[44:47]
    v_mfma_f32_16x16x32_bf16 v[48:51], v[184:187], v[96:99], v[48:51]
    v_mfma_f32_16x16x32_bf16 v[52:55], v[184:187], v[100:103], v[52:55]
    v_mfma_f32_16x16x32_bf16 v[56:59], v[184:187], v[104:107], v[56:59]
    v_mfma_f32_16x16x32_bf16 v[60:63], v[184:187], v[108:111], v[60:63]
    v_mfma_f32_16x16x32_bf16 v[64:67], v[188:191], v[96:99], v[64:67]
    v_mfma_f32_16x16x32_bf16 v[68:71], v[188:191], v[100:103], v[68:71]
    v_mfma_f32_16x16x32_bf16 v[72:75], v[188:191], v[104:107], v[72:75]
    v_mfma_f32_16x16x32_bf16 v[76:79], v[188:191], v[108:111], v[76:79]
    s_waitcnt vmcnt(8)
    v_mfma_f32_16x16x32_bf16 v[16:19], v[192:195], v[112:115], v[16:19]
    s_add_u32 s54, s67, 98304
    v_add_u32 v232, s54, v10
    v_mfma_f32_16x16x32_bf16 v[20:23], v[192:195], v[116:119], v[20:23]
    v_add_u32 v233, s54, v11
    v_add_u32 v234, s54, v12
    v_add_u32 v235, s54, v13
    v_mfma_f32_16x16x32_bf16 v[24:27], v[192:195], v[120:123], v[24:27]
    ds_read_b64_tr_b16 v[96:97], v232 offset:0
    ds_read_b64_tr_b16 v[98:99], v232 offset:2048
    ds_read_b64_tr_b16 v[100:101], v233 offset:0
    v_mfma_f32_16x16x32_bf16 v[28:31], v[192:195], v[124:127], v[28:31]
    ds_read_b64_tr_b16 v[102:103], v233 offset:2048
    ds_read_b64_tr_b16 v[104:105], v234 offset:0
    ds_read_b64_tr_b16 v[106:107], v234 offset:2048
    v_mfma_f32_16x16x32_bf16 v[32:35], v[196:199], v[112:115], v[32:35]
    ds_read_b64_tr_b16 v[108:109], v235 offset:0
    ds_read_b64_tr_b16 v[110:111], v235 offset:2048
    s_waitcnt lgkmcnt(0)
    v_mfma_f32_16x16x32_bf16 v[36:39], v[196:199], v[116:119], v[36:39]
    s_add_u32 s7, s6, 10
    s_cmp_ge_u32 s7, 11
    s_cselect_b32 s3, 11, 0
    v_mfma_f32_16x16x32_bf16 v[40:43], v[196:199], v[120:123], v[40:43]
    s_sub_u32 s7, s7, s3
    s_lshl_b32 s69, s7, 15
    s_add_u32 s69, s69, s72
    v_mfma_f32_16x16x32_bf16 v[44:47], v[196:199], v[124:127], v[44:47]
    s_add_u32 m0, s67, 81920
    s_add_u32 s54, s69, 0
    buffer_load_dwordx4 v4, s[20:23], s54 offen lds
    v_mfma_f32_16x16x32_bf16 v[48:51], v[200:203], v[112:115], v[48:51]
    s_add_u32 m0, s67, 82944
    s_add_u32 s54, s69, 8192
    buffer_load_dwordx4 v4, s[20:23], s54 offen lds
    v_mfma_f32_16x16x32_bf16 v[52:55], v[200:203], v[116:119], v[52:55]
    s_add_u32 m0, s67, 83968
    s_add_u32 s54, s69, 16384
    buffer_load_dwordx4 v4, s[20:23], s54 offen lds
    v_mfma_f32_16x16x32_bf16 v[56:59], v[200:203], v[120:123], v[56:59]
    s_add_u32 m0, s67, 84992
    s_add_u32 s54, s69, 24576
    buffer_load_dwordx4 v4, s[20:23], s54 offen lds
    v_mfma_f32_16x16x32_bf16 v[60:63], v[200:203], v[124:127], v[60:63]
    buffer_load_dwordx4 v[176:179], v244, s[24:27], s61 offen sc1
    buffer_load_dwordx4 v[180:183], v245, s[24:27], s61 offen sc1
    buffer_load_dwordx4 v[184:187], v246, s[24:27], s61 offen sc1
    v_mfma_f32_16x16x32_bf16 v[64:67], v[204:207], v[112:115], v[64:67]
    buffer_load_dwordx4 v[188:191], v247, s[24:27], s61 offen sc1
    v_mfma_f32_16x16x32_bf16 v[68:71], v[204:207], v[116:119], v[68:71]
    v_mfma_f32_16x16x32_bf16 v[72:75], v[204:207], v[120:123], v[72:75]
    v_mfma_f32_16x16x32_bf16 v[76:79], v[204:207], v[124:127], v[76:79]
    s_waitcnt vmcnt(12)
    v_mfma_f32_16x16x32_bf16 v[16:19], v[208:211], v[128:131], v[16:19]
    s_add_u32 s54, s67, 0
    v_add_u32 v232, s54, v10
    v_mfma_f32_16x16x32_bf16 v[20:23], v[208:211], v[132:135], v[20:23]
    v_add_u32 v233, s54, v11
    v_add_u32 v234, s54, v12
    v_add_u32 v235, s54, v13
    v_mfma_f32_16x16x32_bf16 v[24:27], v[208:211], v[136:139], v[24:27]
    ds_read_b64_tr_b16 v[112:113], v232 offset:0
    ds_read_b64_tr_b16 v[114:115], v232 offset:2048
    ds_read_b64_tr_b16 v[116:117], v233 offset:0
    v_mfma_f32_16x16x32_bf16 v[28:31], v[208:211], v[140:143], v[28:31]
    ds_read_b64_tr_b16 v[118:119], v233 offset:2048
    ds_read_b64_tr_b16 v[120:121], v234 offset:0
    ds_read_b64_tr_b16 v[122:123], v234 offset:2048
    v_mfma_f32_16x16x32_bf16 v[32:35], v[212:215], v[128:131], v[32:35]
    ds_read_b64_tr_b16 v[124:125], v235 offset:0
    ds_read_b64_tr_b16 v[126:127], v235 offset:2048
    buffer_load_dwordx4 v[192:195], v244, s[24:27], s62 offen sc1
    v_mfma_f32_16x16x32_bf16 v[36:39], v[212:215], v[132:135], v[36:39]
    buffer_load_dwordx4 v[196:199], v245, s[24:27], s62 offen sc1
    buffer_load_dwordx4 v[200:203], v246, s[24:27], s62 offen sc1
    buffer_load_dwordx4 v[204:207], v247, s[24:27], s62 offen sc1
    v_mfma_f32_16x16x32_bf16 v[40:43], v[212:215], v[136:139], v[40:43]
    v_mfma_f32_16x16x32_bf16 v[44:47], v[212:215], v[140:143], v[44:47]
    v_mfma_f32_16x16x32_bf16 v[48:51], v[216:219], v[128:131], v[48:51]
    v_mfma_f32_16x16x32_bf16 v[52:55], v[216:219], v[132:135], v[52:55]
    v_mfma_f32_16x16x32_bf16 v[56:59], v[216:219], v[136:139], v[56:59]
    v_mfma_f32_16x16x32_bf16 v[60:63], v[216:219], v[140:143], v[60:63]
    v_mfma_f32_16x16x32_bf16 v[64:67], v[220:223], v[128:131], v[64:67]
    v_mfma_f32_16x16x32_bf16 v[68:71], v[220:223], v[132:135], v[68:71]
    v_mfma_f32_16x16x32_bf16 v[72:75], v[220:223], v[136:139], v[72:75]
    v_mfma_f32_16x16x32_bf16 v[76:79], v[220:223], v[140:143], v[76:79]
    s_waitcnt vmcnt(12)
    v_mfma_f32_16x16x32_bf16 v[16:19], v[160:163], v[144:147], v[16:19]
    s_add_u32 s54, s67, 16384
    v_add_u32 v232, s54, v10
    v_mfma_f32_16x16x32_bf16 v[20:23], v[160:163], v[148:151], v[20:23]
    v_add_u32 v233, s54, v11
    v_add_u32 v234, s54, v12
    v_add_u32 v235, s54, v13
    v_mfma_f32_16x16x32_bf16 v[24:27], v[160:163], v[152:155], v[24:27]
    ds_read_b64_tr_b16 v[128:129], v232 offset:0
    ds_read_b64_tr_b16 v[130:131], v232 offset:2048
    ds_read_b64_tr_b16 v[132:133], v233 offset:0
    v_mfma_f32_16x16x32_bf16 v[28:31], v[160:163], v[156:159], v[28:31]
    ds_read_b64_tr_b16 v[134:135], v233 offset:2048
    ds_read_b64_tr_b16 v[136:137], v234 offset:0
    ds_read_b64_tr_b16 v[138:139], v234 offset:2048
    v_mfma_f32_16x16x32_bf16 v[32:35], v[164:167], v[144:147], v[32:35]
    ds_read_b64_tr_b16 v[140:141], v235 offset:0
    ds_read_b64_tr_b16 v[142:143], v235 offset:2048
    buffer_load_dwordx4 v[208:211], v244, s[24:27], s63 offen sc1
    v_mfma_f32_16x16x32_bf16 v[36:39], v[164:167], v[148:151], v[36:39]
    buffer_load_dwordx4 v[212:215], v245, s[24:27], s63 offen sc1
    buffer_load_dwordx4 v[216:219], v246, s[24:27], s63 offen sc1
    buffer_load_dwordx4 v[220:223], v247, s[24:27], s63 offen sc1
    v_mfma_f32_16x16x32_bf16 v[40:43], v[164:167], v[152:155], v[40:43]
    v_mfma_f32_16x16x32_bf16 v[44:47], v[164:167], v[156:159], v[44:47]
    v_mfma_f32_16x16x32_bf16 v[48:51], v[168:171], v[144:147], v[48:51]
    v_mfma_f32_16x16x32_bf16 v[52:55], v[168:171], v[148:151], v[52:55]
    v_mfma_f32_16x16x32_bf16 v[56:59], v[168:171], v[152:155], v[56:59]
    v_mfma_f32_16x16x32_bf16 v[60:63], v[168:171], v[156:159], v[60:63]
    v_mfma_f32_16x16x32_bf16 v[64:67], v[172:175], v[144:147], v[64:67]
    v_mfma_f32_16x16x32_bf16 v[68:71], v[172:175], v[148:151], v[68:71]
    v_mfma_f32_16x16x32_bf16 v[72:75], v[172:175], v[152:155], v[72:75]
    v_mfma_f32_16x16x32_bf16 v[76:79], v[172:175], v[156:159], v[76:79]
    s_waitcnt vmcnt(8)
    v_mfma_f32_16x16x32_bf16 v[16:19], v[176:179], v[80:83], v[16:19]
    s_add_u32 s54, s68, 0
    v_add_u32 v232, s54, v10
    v_mfma_f32_16x16x32_bf16 v[20:23], v[176:179], v[84:87], v[20:23]
    v_add_u32 v233, s54, v11
    v_add_u32 v234, s54, v12
    v_add_u32 v235, s54, v13
    v_mfma_f32_16x16x32_bf16 v[24:27], v[176:179], v[88:91], v[24:27]
    ds_read_b64_tr_b16 v[144:145], v232 offset:0
    ds_read_b64_tr_b16 v[146:147], v232 offset:2048
    ds_read_b64_tr_b16 v[148:149], v233 offset:0
    v_mfma_f32_16x16x32_bf16 v[28:31], v[176:179], v[92:95], v[28:31]
    ds_read_b64_tr_b16 v[150:151], v233 offset:2048
    ds_read_b64_tr_b16 v[152:153], v234 offset:0
    ds_read_b64_tr_b16 v[154:155], v234 offset:2048
    v_mfma_f32_16x16x32_bf16 v[32:35], v[180:183], v[80:83], v[32:35]
    ds_read_b64_tr_b16 v[156:157], v235 offset:0
    ds_read_b64_tr_b16 v[158:159], v235 offset:2048
    buffer_load_dwordx4 v[160:163], v244, s[24:27], s64 offen sc1
    v_mfma_f32_16x16x32_bf16 v[36:39], v[180:183], v[84:87], v[36:39]
    buffer_load_dwordx4 v[164:167], v245, s[24:27], s64 offen sc1
    buffer_load_dwordx4 v[168:171], v246, s[24:27], s64 offen sc1
    buffer_load_dwordx4 v[172:175], v247, s[24:27], s64 offen sc1
    v_mfma_f32_16x16x32_bf16 v[40:43], v[180:183], v[88:91], v[40:43]
    v_mfma_f32_16x16x32_bf16 v[44:47], v[180:183], v[92:95], v[44:47]
    v_mfma_f32_16x16x32_bf16 v[48:51], v[184:187], v[80:83], v[48:51]
    v_mfma_f32_16x16x32_bf16 v[52:55], v[184:187], v[84:87], v[52:55]
    v_mfma_f32_16x16x32_bf16 v[56:59], v[184:187], v[88:91], v[56:59]
    v_mfma_f32_16x16x32_bf16 v[60:63], v[184:187], v[92:95], v[60:63]
    v_mfma_f32_16x16x32_bf16 v[64:67], v[188:191], v[80:83], v[64:67]
    v_mfma_f32_16x16x32_bf16 v[68:71], v[188:191], v[84:87], v[68:71]
    v_mfma_f32_16x16x32_bf16 v[72:75], v[188:191], v[88:91], v[72:75]
    v_mfma_f32_16x16x32_bf16 v[76:79], v[188:191], v[92:95], v[76:79]
    s_waitcnt vmcnt(8)
    v_mfma_f32_16x16x32_bf16 v[16:19], v[192:195], v[96:99], v[16:19]
    s_add_u32 s54, s67, 81920
    v_add_u32 v232, s54, v10
    v_mfma_f32_16x16x32_bf16 v[20:23], v[192:195], v[100:103], v[20:23]
    v_add_u32 v233, s54, v11
    v_add_u32 v234, s54, v12
    v_add_u32 v235, s54, v13
    v_mfma_f32_16x16x32_bf16 v[24:27], v[192:195], v[104:107], v[24:27]
    ds_read_b64_tr_b16 v[80:81], v232 offset:0
    ds_read_b64_tr_b16 v[82:83], v232 offset:2048
    ds_read_b64_tr_b16 v[84:85], v233 offset:0
    v_mfma_f32_16x16x32_bf16 v[28:31], v[192:195], v[108:111], v[28:31]
    ds_read_b64_tr_b16 v[86:87], v233 offset:2048
    ds_read_b64_tr_b16 v[88:89], v234 offset:0
    ds_read_b64_tr_b16 v[90:91], v234 offset:2048
    v_mfma_f32_16x16x32_bf16 v[32:35], v[196:199], v[96:99], v[32:35]
    ds_read_b64_tr_b16 v[92:93], v235 offset:0
    ds_read_b64_tr_b16 v[94:95], v235 offset:2048
    buffer_load_dwordx4 v[176:179], v244, s[24:27], s65 offen sc1
    v_mfma_f32_16x16x32_bf16 v[36:39], v[196:199], v[100:103], v[36:39]
    buffer_load_dwordx4 v[180:183], v245, s[24:27], s65 offen sc1
    buffer_load_dwordx4 v[184:187], v246, s[24:27], s65 offen sc1
    buffer_load_dwordx4 v[188:191], v247, s[24:27], s65 offen sc1
    v_mfma_f32_16x16x32_bf16 v[40:43], v[196:199], v[104:107], v[40:43]
    v_mfma_f32_16x16x32_bf16 v[44:47], v[196:199], v[108:111], v[44:47]
    v_mfma_f32_16x16x32_bf16 v[48:51], v[200:203], v[96:99], v[48:51]
    v_mfma_f32_16x16x32_bf16 v[52:55], v[200:203], v[100:103], v[52:55]
    v_mfma_f32_16x16x32_bf16 v[56:59], v[200:203], v[104:107], v[56:59]
    v_mfma_f32_16x16x32_bf16 v[60:63], v[200:203], v[108:111], v[60:63]
    v_mfma_f32_16x16x32_bf16 v[64:67], v[204:207], v[96:99], v[64:67]
    v_mfma_f32_16x16x32_bf16 v[68:71], v[204:207], v[100:103], v[68:71]
    v_mfma_f32_16x16x32_bf16 v[72:75], v[204:207], v[104:107], v[72:75]
    v_mfma_f32_16x16x32_bf16 v[76:79], v[204:207], v[108:111], v[76:79]
    s_waitcnt vmcnt(8)
    s_waitcnt lgkmcnt(15)
    v_mfma_f32_16x16x32_bf16 v[16:19], v[208:211], v[112:115], v[16:19]
    buffer_load_dwordx4 v[192:195], v244, s[24:27], s66 offen sc1
    buffer_load_dwordx4 v[196:199], v245, s[24:27], s66 offen sc1
    buffer_load_dwordx4 v[200:203], v246, s[24:27], s66 offen sc1
    v_mfma_f32_16x16x32_bf16 v[20:23], v[208:211], v[116:119], v[20:23]
    buffer_load_dwordx4 v[204:207], v247, s[24:27], s66 offen sc1
    v_mfma_f32_16x16x32_bf16 v[24:27], v[208:211], v[120:123], v[24:27]
    v_mfma_f32_16x16x32_bf16 v[28:31], v[208:211], v[124:127], v[28:31]
    v_mfma_f32_16x16x32_bf16 v[32:35], v[212:215], v[112:115], v[32:35]
    v_mfma_f32_16x16x32_bf16 v[36:39], v[212:215], v[116:119], v[36:39]
    v_mfma_f32_16x16x32_bf16 v[40:43], v[212:215], v[120:123], v[40:43]
    v_mfma_f32_16x16x32_bf16 v[44:47], v[212:215], v[124:127], v[44:47]
    v_mfma_f32_16x16x32_bf16 v[48:51], v[216:219], v[112:115], v[48:51]
    v_mfma_f32_16x16x32_bf16 v[52:55], v[216:219], v[116:119], v[52:55]
    v_mfma_f32_16x16x32_bf16 v[56:59], v[216:219], v[120:123], v[56:59]
    v_mfma_f32_16x16x32_bf16 v[60:63], v[216:219], v[124:127], v[60:63]
    v_mfma_f32_16x16x32_bf16 v[64:67], v[220:223], v[112:115], v[64:67]
    v_mfma_f32_16x16x32_bf16 v[68:71], v[220:223], v[116:119], v[68:71]
    v_mfma_f32_16x16x32_bf16 v[72:75], v[220:223], v[120:123], v[72:75]
    v_mfma_f32_16x16x32_bf16 v[76:79], v[220:223], v[124:127], v[76:79]
    buffer_load_dwordx2 v[232:233], v14, s[40:43], s76 offen sc1
    s_waitcnt vmcnt(9)
    v_mfma_f32_16x16x32_bf16 v[16:19], v[160:163], v[128:131], v[16:19]
    v_mfma_f32_16x16x32_bf16 v[20:23], v[160:163], v[132:135], v[20:23]
    v_mfma_f32_16x16x32_bf16 v[24:27], v[160:163], v[136:139], v[24:27]
    v_mfma_f32_16x16x32_bf16 v[28:31], v[160:163], v[140:143], v[28:31]
    v_mfma_f32_16x16x32_bf16 v[32:35], v[164:167], v[128:131], v[32:35]
    v_mfma_f32_16x16x32_bf16 v[36:39], v[164:167], v[132:135], v[36:39]
    v_mfma_f32_16x16x32_bf16 v[40:43], v[164:167], v[136:139], v[40:43]
    v_mfma_f32_16x16x32_bf16 v[44:47], v[164:167], v[140:143], v[44:47]
    v_mfma_f32_16x16x32_bf16 v[48:51], v[168:171], v[128:131], v[48:51]
    v_mfma_f32_16x16x32_bf16 v[52:55], v[168:171], v[132:135], v[52:55]
    v_mfma_f32_16x16x32_bf16 v[56:59], v[168:171], v[136:139], v[56:59]
    v_mfma_f32_16x16x32_bf16 v[60:63], v[168:171], v[140:143], v[60:63]
    v_mfma_f32_16x16x32_bf16 v[64:67], v[172:175], v[128:131], v[64:67]
    v_mfma_f32_16x16x32_bf16 v[68:71], v[172:175], v[132:135], v[68:71]
    v_mfma_f32_16x16x32_bf16 v[72:75], v[172:175], v[136:139], v[72:75]
    v_mfma_f32_16x16x32_bf16 v[76:79], v[172:175], v[140:143], v[76:79]
    s_waitcnt vmcnt(5)
    s_waitcnt lgkmcnt(14)
    v_mfma_f32_16x16x32_bf16 v[16:19], v[176:179], v[144:147], v[16:19]
    s_waitcnt lgkmcnt(12)
    v_mfma_f32_16x16x32_bf16 v[20:23], v[176:179], v[148:151], v[20:23]
    s_waitcnt lgkmcnt(10)
    v_mfma_f32_16x16x32_bf16 v[24:27], v[176:179], v[152:155], v[24:27]
    s_waitcnt lgkmcnt(8)
    v_mfma_f32_16x16x32_bf16 v[28:31], v[176:179], v[156:159], v[28:31]
    v_mfma_f32_16x16x32_bf16 v[32:35], v[180:183], v[144:147], v[32:35]
    v_mfma_f32_16x16x32_bf16 v[36:39], v[180:183], v[148:151], v[36:39]
    v_mfma_f32_16x16x32_bf16 v[40:43], v[180:183], v[152:155], v[40:43]
    v_mfma_f32_16x16x32_bf16 v[44:47], v[180:183], v[156:159], v[44:47]
    v_mfma_f32_16x16x32_bf16 v[48:51], v[184:187], v[144:147], v[48:51]
    v_mfma_f32_16x16x32_bf16 v[52:55], v[184:187], v[148:151], v[52:55]
    v_mfma_f32_16x16x32_bf16 v[56:59], v[184:187], v[152:155], v[56:59]
    v_mfma_f32_16x16x32_bf16 v[60:63], v[184:187], v[156:159], v[60:63]
    v_mfma_f32_16x16x32_bf16 v[64:67], v[188:191], v[144:147], v[64:67]
    v_mfma_f32_16x16x32_bf16 v[68:71], v[188:191], v[148:151], v[68:71]
    v_mfma_f32_16x16x32_bf16 v[72:75], v[188:191], v[152:155], v[72:75]
    v_mfma_f32_16x16x32_bf16 v[76:79], v[188:191], v[156:159], v[76:79]
    s_waitcnt vmcnt(1)
    s_waitcnt lgkmcnt(6)
    v_mfma_f32_16x16x32_bf16 v[16:19], v[192:195], v[80:83], v[16:19]
    s_waitcnt lgkmcnt(4)
    v_mfma_f32_16x16x32_bf16 v[20:23], v[192:195], v[84:87], v[20:23]
    s_waitcnt lgkmcnt(2)
    v_mfma_f32_16x16x32_bf16 v[24:27], v[192:195], v[88:91], v[24:27]
    s_waitcnt lgkmcnt(0)
    v_mfma_f32_16x16x32_bf16 v[28:31], v[192:195], v[92:95], v[28:31]
    v_mfma_f32_16x16x32_bf16 v[32:35], v[196:199], v[80:83], v[32:35]
    v_mfma_f32_16x16x32_bf16 v[36:39], v[196:199], v[84:87], v[36:39]
    v_mfma_f32_16x16x32_bf16 v[40:43], v[196:199], v[88:91], v[40:43]
    v_mfma_f32_16x16x32_bf16 v[44:47], v[196:199], v[92:95], v[44:47]
    v_mfma_f32_16x16x32_bf16 v[48:51], v[200:203], v[80:83], v[48:51]
    v_mfma_f32_16x16x32_bf16 v[52:55], v[200:203], v[84:87], v[52:55]
    v_mfma_f32_16x16x32_bf16 v[56:59], v[200:203], v[88:91], v[56:59]
    v_mfma_f32_16x16x32_bf16 v[60:63], v[200:203], v[92:95], v[60:63]
    v_mfma_f32_16x16x32_bf16 v[64:67], v[204:207], v[80:83], v[64:67]
    v_mfma_f32_16x16x32_bf16 v[68:71], v[204:207], v[84:87], v[68:71]
    v_mfma_f32_16x16x32_bf16 v[72:75], v[204:207], v[88:91], v[72:75]
    v_mfma_f32_16x16x32_bf16 v[76:79], v[204:207], v[92:95], v[76:79]
    s_waitcnt vmcnt(0)
    s_mov_b32 s55, 200000
G_FAW:
    v_xor_b32 v232, s49, v232
    v_xor_b32 v233, s49, v233
    v_or_b32 v232, v232, v233
    v_cmp_eq_u32 vcc, 0, v232
    s_cmp_eq_u64 vcc, -1
    s_cbranch_scc1 G_ATOK
    s_sleep 1
    buffer_load_dwordx2 v[232:233], v14, s[40:43], s76 offen sc1
    s_waitcnt vmcnt(0)
    s_sub_u32 s55, s55, 1
    s_cmp_lg_u32 s55, 0
    s_cbranch_scc1 G_FAW
G_ATOK:
    s_mov_b32 s53, s77
    buffer_load_dwordx2 v[236:237], v7, s[32:35], s53 offen sc1
    s_add_u32 s53, s53, 65536
    buffer_load_dwordx2 v[238:239], v7, s[32:35], s53 offen sc1
    s_add_u32 s53, s53, 65536
    buffer_load_dwordx2 v[240:241], v7, s[32:35], s53 offen sc1
    s_add_u32 s53, s53, 65536
    buffer_load_dwordx2 v[242:243], v7, s[32:35], s53 offen sc1
    s_waitcnt lgkmcnt(0)
    s_barrier
    s_add_u32 s53, s45, 1
    s_and_b32 s53, s53, 3
    s_mul_i32 s53, s53, 12288
    s_add_u32 s53, s53, 0
    v_add_u32 v9, s53, v3
    ds_write_b128 v9, v[32:35] offset:0
    ds_write_b128 v9, v[36:39] offset:1024
    ds_write_b128 v9, v[40:43] offset:2048
    ds_write_b128 v9, v[44:47] offset:3072
    s_add_u32 s53, s45, 2
    s_and_b32 s53, s53, 3
    s_mul_i32 s53, s53, 12288
    s_add_u32 s53, s53, 4096
    v_add_u32 v9, s53, v3
    ds_write_b128 v9, v[48:51] offset:0
    ds_write_b128 v9, v[52:55] offset:1024
    ds_write_b128 v9, v[56:59] offset:2048
    ds_write_b128 v9, v[60:63] offset:3072
    s_add_u32 s53, s45, 3
    s_and_b32 s53, s53, 3
    s_mul_i32 s53, s53, 12288
    s_add_u32 s53, s53, 8192
    v_add_u32 v9, s53, v3
    ds_write_b128 v9, v[64:67] offset:0
    ds_write_b128 v9, v[68:71] offset:1024
    ds_write_b128 v9, v[72:75] offset:2048
    ds_write_b128 v9, v[76:79] offset:3072
    s_waitcnt vmcnt(0)
    v_lshlrev_b32 v112, 16, v224
    v_and_b32 v113, 0xffff0000, v224
    v_lshlrev_b32 v114, 16, v236
    v_and_b32 v115, 0xffff0000, v236
    v_pk_add_f32 v[112:113], v[112:113], v[114:115]
    v_cvt_pk_bf16_f32 v112, v112, v113
    v_lshlrev_b32 v96, 16, v112
    v_and_b32 v97, 0xffff0000, v112
    v_lshlrev_b32 v112, 16, v225
    v_and_b32 v113, 0xffff0000, v225
    v_lshlrev_b32 v114, 16, v237
    v_and_b32 v115, 0xffff0000, v237
    v_pk_add_f32 v[112:113], v[112:113], v[114:115]
    v_cvt_pk_bf16_f32 v112, v112, v113
    v_lshlrev_b32 v98, 16, v112
    v_and_b32 v99, 0xffff0000, v112
    v_lshlrev_b32 v112, 16, v226
    v_and_b32 v113, 0xffff0000, v226
    v_lshlrev_b32 v114, 16, v238
    v_and_b32 v115, 0xffff0000, v238
    v_pk_add_f32 v[112:113], v[112:113], v[114:115]
    v_cvt_pk_bf16_f32 v112, v112, v113
    v_lshlrev_b32 v100, 16, v112
    v_and_b32 v101, 0xffff0000, v112
    v_lshlrev_b32 v112, 16, v227
    v_and_b32 v113, 0xffff0000, v227
    v_lshlrev_b32 v114, 16, v239
    v_and_b32 v115, 0xffff0000, v239
    v_pk_add_f32 v[112:113], v[112:113], v[114:115]
    v_cvt_pk_bf16_f32 v112, v112, v113
    v_lshlrev_b32 v102, 16, v112
    v_and_b32 v103, 0xffff0000, v112
    v_lshlrev_b32 v112, 16, v228
    v_and_b32 v113, 0xffff0000, v228
    v_lshlrev_b32 v114, 16, v240
    v_and_b32 v115, 0xffff0000, v240
    v_pk_add_f32 v[112:113], v[112:113], v[114:115]
    v_cvt_pk_bf16_f32 v112, v112, v113
    v_lshlrev_b32 v104, 16, v112
    v_and_b32 v105, 0xffff0000, v112
    v_lshlrev_b32 v112, 16, v229
    v_and_b32 v113, 0xffff0000, v229
    v_lshlrev_b32 v114, 16, v241
    v_and_b32 v115, 0xffff0000, v241
    v_pk_add_f32 v[112:113], v[112:113], v[114:115]
    v_cvt_pk_bf16_f32 v112, v112, v113
    v_lshlrev_b32 v106, 16, v112
    v_and_b32 v107, 0xffff0000, v112
    v_lshlrev_b32 v112, 16, v230
    v_and_b32 v113, 0xffff0000, v230
    v_lshlrev_b32 v114, 16, v242
    v_and_b32 v115, 0xffff0000, v242
    v_pk_add_f32 v[112:113], v[112:113], v[114:115]
    v_cvt_pk_bf16_f32 v112, v112, v113
    v_lshlrev_b32 v108, 16, v112
    v_and_b32 v109, 0xffff0000, v112
    v_lshlrev_b32 v112, 16, v231
    v_and_b32 v113, 0xffff0000, v231
    v_lshlrev_b32 v114, 16, v243
    v_and_b32 v115, 0xffff0000, v243
    v_pk_add_f32 v[112:113], v[112:113], v[114:115]
    v_cvt_pk_bf16_f32 v112, v112, v113
    v_lshlrev_b32 v110, 16, v112
    v_and_b32 v111, 0xffff0000, v112
    s_waitcnt lgkmcnt(0)
    s_barrier
    s_mul_i32 s54, s45, 12288
    v_add_u32 v9, s54, v3
    ds_read_b128 v[128:131], v9 offset:0
    ds_read_b128 v[132:135], v9 offset:1024
    ds_read_b128 v[136:139], v9 offset:2048
    ds_read_b128 v[140:143], v9 offset:3072
    ds_read_b128 v[144:147], v9 offset:4096
    ds_read_b128 v[148:151], v9 offset:5120
    ds_read_b128 v[152:155], v9 offset:6144
    ds_read_b128 v[156:159], v9 offset:7168
    ds_read_b128 v[160:163], v9 offset:8192
    ds_read_b128 v[164:167], v9 offset:9216
    ds_read_b128 v[168:171], v9 offset:10240
    ds_read_b128 v[172:175], v9 offset:11264
    v_mul_u32_u24 v8, 32, v5
    v_lshl_add_u32 v8, v6, 3, v8
    v_add_u32 v8, s79, v8
    v_lshrrev_b32 v9, 2, v5
    v_lshl_add_u32 v9, v6, 3, v9
    v_mul_u32_u24 v9, 32, v9
    v_and_b32 v10, 3, v5
    v_lshl_add_u32 v9, v10, 3, v9
    v_add_u32 v9, s79, v9
    v_lshlrev_b32 v10, 10, v5
    v_lshl_add_u32 v10, v6, 4, v10
    s_waitcnt lgkmcnt(0)
    v_pk_add_f32 v[16:17], v[16:17], v[128:129]
    v_pk_add_f32 v[144:145], v[144:145], v[160:161]
    v_pk_add_f32 v[18:19], v[18:19], v[130:131]
    v_pk_add_f32 v[146:147], v[146:147], v[162:163]
    v_pk_add_f32 v[16:17], v[16:17], v[144:145]
    v_pk_add_f32 v[18:19], v[18:19], v[146:147]
    v_cvt_pk_bf16_f32 v112, v16, v17
    v_cvt_pk_bf16_f32 v113, v18, v19
    v_lshlrev_b32 v16, 16, v112
    v_and_b32 v17, 0xffff0000, v112
    v_lshlrev_b32 v18, 16, v113
    v_and_b32 v19, 0xffff0000, v113
    v_pk_add_f32 v[16:17], v[16:17], v[96:97]
    v_pk_add_f32 v[18:19], v[18:19], v[98:99]
    v_cvt_pk_bf16_f32 v116, v16, v17
    v_cvt_pk_bf16_f32 v117, v18, v19
    ds_write_b64 v8, v[116:117] offset:0
    v_pk_add_f32 v[20:21], v[20:21], v[132:133]
    v_pk_add_f32 v[148:149], v[148:149], v[164:165]
    v_pk_add_f32 v[22:23], v[22:23], v[134:135]
    v_pk_add_f32 v[150:151], v[150:151], v[166:167]
    v_pk_add_f32 v[20:21], v[20:21], v[148:149]
    v_pk_add_f32 v[22:23], v[22:23], v[150:151]
    v_cvt_pk_bf16_f32 v112, v20, v21
    v_cvt_pk_bf16_f32 v113, v22, v23
    v_lshlrev_b32 v20, 16, v112
    v_and_b32 v21, 0xffff0000, v112
    v_lshlrev_b32 v22, 16, v113
    v_and_b32 v23, 0xffff0000, v113
    v_pk_add_f32 v[20:21], v[20:21], v[100:101]
    v_pk_add_f32 v[22:23], v[22:23], v[102:103]
    v_cvt_pk_bf16_f32 v118, v20, v21
    v_cvt_pk_bf16_f32 v119, v22, v23
    ds_write_b64 v8, v[118:119] offset:512
    v_pk_add_f32 v[24:25], v[24:25], v[136:137]
    v_pk_add_f32 v[152:153], v[152:153], v[168:169]
    v_pk_add_f32 v[26:27], v[26:27], v[138:139]
    v_pk_add_f32 v[154:155], v[154:155], v[170:171]
    v_pk_add_f32 v[24:25], v[24:25], v[152:153]
    v_pk_add_f32 v[26:27], v[26:27], v[154:155]
    v_cvt_pk_bf16_f32 v112, v24, v25
    v_cvt_pk_bf16_f32 v113, v26, v27
    v_lshlrev_b32 v24, 16, v112
    v_and_b32 v25, 0xffff0000, v112
    v_lshlrev_b32 v26, 16, v113
    v_and_b32 v27, 0xffff0000, v113
    v_pk_add_f32 v[24:25], v[24:25], v[104:105]
    v_pk_add_f32 v[26:27], v[26:27], v[106:107]
    v_cvt_pk_bf16_f32 v120, v24, v25
    v_cvt_pk_bf16_f32 v121, v26, v27
    ds_write_b64 v8, v[120:121] offset:1024
    v_pk_add_f32 v[28:29], v[28:29], v[140:141]
    v_pk_add_f32 v[156:157], v[156:157], v[172:173]
    v_pk_add_f32 v[30:31], v[30:31], v[142:143]
    v_pk_add_f32 v[158:159], v[158:159], v[174:175]
    v_pk_add_f32 v[28:29], v[28:29], v[156:157]
    v_pk_add_f32 v[30:31], v[30:31], v[158:159]
    v_cvt_pk_bf16_f32 v112, v28, v29
    v_cvt_pk_bf16_f32 v113, v30, v31
    v_lshlrev_b32 v28, 16, v112
    v_and_b32 v29, 0xffff0000, v112
    v_lshlrev_b32 v30, 16, v113
    v_and_b32 v31, 0xffff0000, v113
    v_pk_add_f32 v[28:29], v[28:29], v[108:109]
    v_pk_add_f32 v[30:31], v[30:31], v[110:111]
    v_cvt_pk_bf16_f32 v122, v28, v29
    v_cvt_pk_bf16_f32 v123, v30, v31
    ds_write_b64 v8, v[122:123] offset:1536
    s_waitcnt lgkmcnt(0)
    ds_read_b64_tr_b16 v[128:129], v9 offset:0
    ds_read_b64_tr_b16 v[130:131], v9 offset:128
    ds_read_b64_tr_b16 v[132:133], v9 offset:1024
    ds_read_b64_tr_b16 v[134:135], v9 offset:1152
    s_waitcnt lgkmcnt(0)
    buffer_store_dwordx4 v[128:131], v10, s[36:39], s75 offen offset:0
    buffer_store_dwordx4 v[132:135], v10, s[36:39], s75 offen offset:64
    s_endpgm
S_PATH:
    s_lshr_b32 s70, s45, 1
    s_and_b32 s71, s45, 1
    s_lshl_b32 s53, s50, 9
    s_lshl_b32 s54, s45, 7
    s_add_u32 s53, s53, s54
    v_lshlrev_b32 v3, 1, v1
    v_add_u32 v3, s53, v3
    global_load_ushort v200, v3, s[58:59]
    global_load_ushort v201, v3, s[60:61]
    global_load_ushort v202, v3, s[62:63]
    global_load_ushort v203, v3, s[64:65]
    s_lshl_b32 s54, s50, 2
    v_mov_b32 v3, s54
    global_load_dword v204, v3, s[66:67]
    global_load_dword v205, v3, s[68:69]
    v_lshrrev_b32 v3, 3, v1
    v_and_b32 v4, 7, v1
    v_lshrrev_b32 v5, 1, v3
    v_xor_b32 v6, v4, v5
    v_xor_b32 v7, 4, v6
    v_lshlrev_b32 v3, 10, v3
    v_lshl_add_u32 v195, v6, 4, v3
    v_lshl_add_u32 v196, v7, 4, v3
    v_add_u32 v3, 0, v1
    v_mul_u32_u24 v4, 5462, v3
    v_lshrrev_b32 v4, 16, v4
    v_mul_u32_u24 v5, 12, v4
    v_sub_u32 v5, v3, v5
    v_bfe_u32 v6, v4, 3, 1
    v_lshlrev_b32 v6, 1, v6
    v_xor_b32 v5, v5, v6
    v_mul_u32_u24 v4, 2752, v4
    v_lshl_add_u32 v197, v5, 4, v4
    v_add_u32 v3, 64, v1
    v_mul_u32_u24 v4, 5462, v3
    v_lshrrev_b32 v4, 16, v4
    v_mul_u32_u24 v5, 12, v4
    v_sub_u32 v5, v3, v5
    v_bfe_u32 v6, v4, 3, 1
    v_lshlrev_b32 v6, 1, v6
    v_xor_b32 v5, v5, v6
    v_mul_u32_u24 v4, 2752, v4
    v_lshl_add_u32 v198, v5, 4, v4
    v_add_u32 v3, 128, v1
    v_mul_u32_u24 v4, 5462, v3
    v_lshrrev_b32 v4, 16, v4
    v_mul_u32_u24 v5, 12, v4
    v_sub_u32 v5, v3, v5
    v_bfe_u32 v6, v4, 3, 1
    v_lshlrev_b32 v6, 1, v6
    v_xor_b32 v5, v5, v6
    v_mul_u32_u24 v4, 2752, v4
    v_lshl_add_u32 v199, v5, 4, v4
    s_lshl_b32 s6, s47, 1
    s_add_u32 s6, s6, s46
    s_and_b32 s6, s6, 7
    s_lshl_b32 s76, s46, 17
    s_lshl_b32 s53, s45, 15
    s_add_u32 s76, s76, s53
    s_mul_i32 s77, s45, 44032
    s_lshl_b32 s53, s48, 6
    s_add_u32 s77, s77, s53
    s_lshl_b32 s78, s45, 12
    s_mul_i32 s79, s45, 3072
    s_add_u32 s79, s79, 16384
    s_add_u32 s7, s6, 0
    s_and_b32 s7, s7, 7
    s_mul_i32 s3, s7, 176128
    s_add_u32 s3, s3, s77
    s_add_u32 m0, s79, 0
    s_nop 0
    buffer_load_dwordx4 v197, s[12:15], s3 offen lds
    s_add_u32 m0, s79, 1024
    s_nop 0
    buffer_load_dwordx4 v198, s[12:15], s3 offen lds
    s_add_u32 m0, s79, 2048
    s_nop 0
    buffer_load_dwordx4 v199, s[12:15], s3 offen lds
    s_add_u32 m0, s79, 12288
    s_nop 0
    buffer_load_dwordx4 v197, s[16:19], s3 offen lds
    s_add_u32 m0, s79, 13312
    s_nop 0
    buffer_load_dwordx4 v198, s[16:19], s3 offen lds
    s_add_u32 m0, s79, 14336
    s_nop 0
    buffer_load_dwordx4 v199, s[16:19], s3 offen lds
    s_mul_i32 s67, s45, 4352
    s_add_u32 s67, s67, 122880
    s_mul_i32 s66, s45, 8704
    s_add_u32 s66, s66, 81920
    v_lshlrev_b32 v30, 2, v1
    v_add_u32 v28, s67, v30
    v_add_u32 v31, s66, v30
    v_and_b32 v29, 15, v1
    v_mul_u32_u24 v29, 272, v29
    v_lshrrev_b32 v32, 4, v1
    v_lshl_add_u32 v29, v32, 4, v29
    v_add_u32 v33, s66, v29
    v_add_u32 v29, s67, v29
    s_xor_b32 s53, s45, 1
    s_mul_i32 s53, s53, 4352
    s_add_u32 s53, s53, 122880
    v_add_u32 v219, s53, v30
    v_and_b32 v40, 15, v1
    v_lshlrev_b32 v40, 3, v40
    v_lshrrev_b32 v41, 4, v1
    v_lshrrev_b32 v42, 1, v41
    v_lshlrev_b32 v42, 7, v42
    v_and_b32 v43, 1, v41
    v_lshl_add_u32 v42, v43, 2, v42
    v_add_u32 v42, v42, v40
    v_cmp_gt_u32 vcc, 2, v41
    v_lshlrev_b32 v43, 7, v41
    v_add_u32 v43, 256, v43
    v_lshlrev_b32 v44, 8, v41
    v_cndmask_b32 v43, v44, v43, vcc
    v_add_u32 v43, v43, v40
    v_mov_b32 v48, 4
    v_mov_b32 v52, 2
    v_cndmask_b32 v48, v48, v52, vcc
    v_mov_b32 v49, 128
    v_mov_b32 v53, 4
    v_cndmask_b32 v49, v49, v53, vcc
    v_mov_b32 v50, 132
    v_mov_b32 v54, 6
    v_cndmask_b32 v50, v50, v54, vcc
    v_lshlrev_b32 v44, 9, v41
    v_add_u32 v44, 1024, v44
    v_add_u32 v44, v44, v40
    s_lshl_b32 s68, s70, 1
    s_add_u32 s68, s68, 0x13444
    s_cmp_eq_u32 s71, 0
    s_cbranch_scc0 SSM_HF1p
    v_add_u32 v226, 0, v42
    v_add_u32 v227, 1, v42
    v_add_u32 v228, 2, v42
    v_add_u32 v229, 3, v42
    v_mov_b32 v230, v43
    v_add_u32 v231, v43, v48
    v_cvt_f32_u32 v226, v226
    v_lshrrev_b32 v226, 14, v226
    v_max_u32 v226, 65020, v226
    v_cvt_f32_u32 v227, v227
    v_lshrrev_b32 v227, 14, v227
    v_max_u32 v227, 65020, v227
    v_cvt_f32_u32 v228, v228
    v_lshrrev_b32 v228, 14, v228
    v_max_u32 v228, 65020, v228
    v_cvt_f32_u32 v229, v229
    v_lshrrev_b32 v229, 14, v229
    v_max_u32 v229, 65020, v229
    v_cvt_f32_u32 v230, v230
    v_lshrrev_b32 v230, 14, v230
    v_max_u32 v230, 65020, v230
    v_cvt_f32_u32 v231, v231
    v_lshrrev_b32 v231, 14, v231
    v_max_u32 v231, 65020, v231
    v_add_u32 v226, s68, v226
    v_add_u32 v227, s68, v227
    v_add_u32 v228, s68, v228
    v_add_u32 v229, s68, v229
    v_add_u32 v230, s68, v230
    v_add_u32 v231, s68, v231
    s_branch SSM_HFXp
SSM_HF1p:
    v_add_u32 v226, v43, v49
    v_add_u32 v227, v43, v50
    v_add_u32 v228, 0, v44
    v_add_u32 v229, 128, v44
    v_add_u32 v230, 256, v44
    v_add_u32 v231, 384, v44
    v_cvt_f32_u32 v226, v226
    v_lshrrev_b32 v226, 14, v226
    v_max_u32 v226, 65020, v226
    v_cvt_f32_u32 v227, v227
    v_lshrrev_b32 v227, 14, v227
    v_max_u32 v227, 65020, v227
    v_cvt_f32_u32 v228, v228
    v_lshrrev_b32 v228, 14, v228
    v_max_u32 v228, 65020, v228
    v_cvt_f32_u32 v229, v229
    v_lshrrev_b32 v229, 14, v229
    v_max_u32 v229, 65020, v229
    v_cvt_f32_u32 v230, v230
    v_lshrrev_b32 v230, 14, v230
    v_max_u32 v230, 65020, v230
    v_cvt_f32_u32 v231, v231
    v_lshrrev_b32 v231, 14, v231
    v_max_u32 v231, 65020, v231
    v_mov_b32 v45, 143904
    s_mov_b32 s53, 70656
    v_add_u32 v226, s68, v226
    v_add_u32 v227, s68, v227
    v_cmp_ge_u32 vcc, s53, v228
    v_add_u32 v228, s68, v228
    s_nop 0
    v_cndmask_b32 v228, v45, v228, vcc
    v_cmp_ge_u32 vcc, s53, v229
    v_add_u32 v229, s68, v229
    s_nop 0
    v_cndmask_b32 v229, v45, v229, vcc
    v_cmp_ge_u32 vcc, s53, v230
    v_add_u32 v230, s68, v230
    s_nop 0
    v_cndmask_b32 v230, v45, v230, vcc
    v_cmp_ge_u32 vcc, s53, v231
    v_add_u32 v231, s68, v231
    s_nop 0
    v_cndmask_b32 v231, v45, v231, vcc
SSM_HFXp:
    s_mov_b32 s69, 1069066811
    s_waitcnt vmcnt(6)
    v_readfirstlane_b32 s72, v204
    s_lshl_b32 s53, s72, 16
    s_and_b32 s54, s72, 0xffff0000
    s_cmp_eq_u32 s70, 0
    s_cselect_b32 s72, s53, s54
    v_mov_b32 v9, s72
    v_mul_f32 v9, s69, v9
    v_exp_f32 v9, v9
    v_lshlrev_b32 v4, 16, v200
    v_lshlrev_b32 v5, 16, v201
    v_lshlrev_b32 v6, 16, v202
    v_lshlrev_b32 v7, 16, v203
    v_mul_f32 v4, s69, v4
    v_exp_f32 v4, v4
    v_cvt_pk_bf16_f32 v9, v9, v9
    v_and_b32 v9, 0xffff0000, v9
    v_cvt_pk_bf16_f32 v4, v4, v4
    v_and_b32 v4, 0xffff0000, v4
    v_mul_f32 v4, v4, v9
    v_mul_f32 v5, v5, v9
    v_mul_f32 v4, s69, v4
    v_mul_f32 v5, 0x3e22f983, v5
    v_add_f32 v9, v9, v9
    v_mul_f32 v16, v6, v9
    v_mul_f32 v17, v7, v9
    v_mul_f32 v10, 0x3f800000, v4
    v_mul_f32 v11, 0x3f800000, v5
    v_mul_f32 v12, 0x41000000, v4
    v_mul_f32 v13, 0x41000000, v5
    v_mul_f32 v14, 0x43000000, v4
    v_mul_f32 v15, 0x43000000, v5
    v_exp_f32 v10, -v10
    v_fract_f32 v11, v11
    v_exp_f32 v12, -v12
    v_fract_f32 v13, v13
    v_exp_f32 v14, -v14
    v_fract_f32 v15, v15
    v_cos_f32 v18, v11
    v_sin_f32 v19, v11
    v_cos_f32 v20, v13
    v_sin_f32 v21, v13
    v_cos_f32 v22, v15
    v_sin_f32 v23, v15
    v_mul_f32 v18, v18, v10
    v_mul_f32 v19, v19, v10
    v_mul_f32 v20, v20, v12
    v_mul_f32 v21, v21, v12
    v_mul_f32 v22, v22, v14
    v_mul_f32 v23, v23, v14
    v_pk_mul_f32 v[24:25], v[18:19], v[18:19] op_sel:[0,0] op_sel_hi:[1,0]
    v_pk_fma_f32 v[24:25], v[18:19], v[18:19], v[24:25] op_sel:[1,1,0] op_sel_hi:[0,1,1] neg_lo:[0,1,0]
    v_pk_mul_f32 v[26:27], v[24:25], v[24:25] op_sel:[0,0] op_sel_hi:[1,0]
    v_pk_fma_f32 v[26:27], v[24:25], v[24:25], v[26:27] op_sel:[1,1,0] op_sel_hi:[0,1,1] neg_lo:[0,1,0]
    s_add_u32 s7, s6, 0
    s_and_b32 s7, s7, 7
    s_lshl_b32 s7, s7, 7
    s_add_u32 s7, s7, s76
    s_add_u32 m0, s78, 0
    s_add_u32 s53, s7, 0
    buffer_load_dwordx4 v195, s[8:11], s53 offen lds
    s_add_u32 m0, s78, 1024
    s_add_u32 s53, s7, 8192
    buffer_load_dwordx4 v196, s[8:11], s53 offen lds
    s_add_u32 m0, s78, 2048
    s_add_u32 s53, s7, 16384
    buffer_load_dwordx4 v195, s[8:11], s53 offen lds
    s_add_u32 m0, s78, 3072
    s_add_u32 s53, s7, 24576
    buffer_load_dwordx4 v196, s[8:11], s53 offen lds
    v_cvt_pk_bf16_f32 v35, v16, -v17
    v_mov_b32 v36, 0x3f80
    v_cvt_pk_bf16_f32 v34, v22, v23
    v_pk_mul_f32 v[44:45], v[22:23], v[22:23] op_sel:[0,0] op_sel_hi:[1,0]
    ds_write_b32 v28, v35 offset:0
    ds_write_b32 v31, v36 offset:0
    ds_write_b32 v31, v34 offset:2176
    v_pk_fma_f32 v[44:45], v[22:23], v[22:23], v[44:45] op_sel:[1,1,0] op_sel_hi:[0,1,1] neg_lo:[0,1,0]
    v_pk_mul_f32 v[62:63], v[16:17], v[20:21] op_sel:[0,0] op_sel_hi:[1,0]
    v_cvt_pk_bf16_f32 v36, v18, v19
    v_pk_mul_f32 v[70:71], v[22:23], v[18:19] op_sel:[0,0] op_sel_hi:[1,0]
    v_pk_mul_f32 v[46:47], v[44:45], v[22:23] op_sel:[0,0] op_sel_hi:[1,0]
    v_pk_fma_f32 v[62:63], v[16:17], v[20:21], v[62:63] op_sel:[1,1,0] op_sel_hi:[0,1,1] neg_lo:[0,1,0]
    ds_write_b32 v31, v36 offset:272
    v_pk_fma_f32 v[70:71], v[22:23], v[18:19], v[70:71] op_sel:[1,1,0] op_sel_hi:[0,1,1] neg_lo:[0,1,0]
    v_pk_fma_f32 v[46:47], v[44:45], v[22:23], v[46:47] op_sel:[1,1,0] op_sel_hi:[0,1,1] neg_lo:[0,1,0]
    v_cvt_pk_bf16_f32 v35, v62, -v63
    v_cvt_pk_bf16_f32 v36, v24, v25
    v_cvt_pk_bf16_f32 v34, v70, v71
    v_pk_mul_f32 v[48:49], v[46:47], v[22:23] op_sel:[0,0] op_sel_hi:[1,0]
    ds_write_b32 v28, v35 offset:272
    ds_write_b32 v31, v36 offset:544
    ds_write_b32 v31, v34 offset:2448
    v_pk_fma_f32 v[48:49], v[46:47], v[22:23], v[48:49] op_sel:[1,1,0] op_sel_hi:[0,1,1] neg_lo:[0,1,0]
    v_pk_mul_f32 v[60:61], v[62:63], v[20:21] op_sel:[0,0] op_sel_hi:[1,0]
    v_pk_mul_f32 v[66:67], v[24:25], v[18:19] op_sel:[0,0] op_sel_hi:[1,0]
    v_pk_mul_f32 v[68:69], v[70:71], v[18:19] op_sel:[0,0] op_sel_hi:[1,0]
    v_pk_mul_f32 v[50:51], v[48:49], v[22:23] op_sel:[0,0] op_sel_hi:[1,0]
    v_pk_fma_f32 v[60:61], v[62:63], v[20:21], v[60:61] op_sel:[1,1,0] op_sel_hi:[0,1,1] neg_lo:[0,1,0]
    v_pk_fma_f32 v[66:67], v[24:25], v[18:19], v[66:67] op_sel:[1,1,0] op_sel_hi:[0,1,1] neg_lo:[0,1,0]
    v_pk_fma_f32 v[68:69], v[70:71], v[18:19], v[68:69] op_sel:[1,1,0] op_sel_hi:[0,1,1] neg_lo:[0,1,0]
    v_pk_fma_f32 v[50:51], v[48:49], v[22:23], v[50:51] op_sel:[1,1,0] op_sel_hi:[0,1,1] neg_lo:[0,1,0]
    v_cvt_pk_bf16_f32 v35, v60, -v61
    v_cvt_pk_bf16_f32 v36, v66, v67
    v_cvt_pk_bf16_f32 v34, v68, v69
    v_pk_mul_f32 v[52:53], v[50:51], v[22:23] op_sel:[0,0] op_sel_hi:[1,0]
    ds_write_b32 v28, v35 offset:544
    ds_write_b32 v31, v36 offset:816
    ds_write_b32 v31, v34 offset:2720
    v_pk_fma_f32 v[52:53], v[50:51], v[22:23], v[52:53] op_sel:[1,1,0] op_sel_hi:[0,1,1] neg_lo:[0,1,0]
    v_pk_mul_f32 v[62:63], v[60:61], v[20:21] op_sel:[0,0] op_sel_hi:[1,0]
    v_pk_mul_f32 v[64:65], v[66:67], v[18:19] op_sel:[0,0] op_sel_hi:[1,0]
    v_pk_mul_f32 v[70:71], v[68:69], v[18:19] op_sel:[0,0] op_sel_hi:[1,0]
    v_pk_mul_f32 v[54:55], v[52:53], v[22:23] op_sel:[0,0] op_sel_hi:[1,0]
    v_pk_fma_f32 v[62:63], v[60:61], v[20:21], v[62:63] op_sel:[1,1,0] op_sel_hi:[0,1,1] neg_lo:[0,1,0]
    v_pk_fma_f32 v[64:65], v[66:67], v[18:19], v[64:65] op_sel:[1,1,0] op_sel_hi:[0,1,1] neg_lo:[0,1,0]
    v_pk_fma_f32 v[70:71], v[68:69], v[18:19], v[70:71] op_sel:[1,1,0] op_sel_hi:[0,1,1] neg_lo:[0,1,0]
    v_pk_fma_f32 v[54:55], v[52:53], v[22:23], v[54:55] op_sel:[1,1,0] op_sel_hi:[0,1,1] neg_lo:[0,1,0]
    v_cvt_pk_bf16_f32 v35, v62, -v63
    v_cvt_pk_bf16_f32 v36, v64, v65
    v_cvt_pk_bf16_f32 v34, v70, v71
    v_pk_mul_f32 v[104:105], v[54:55], v[22:23] op_sel:[0,0] op_sel_hi:[1,0]
    ds_write_b32 v28, v35 offset:816
    ds_write_b32 v31, v36 offset:1088
    ds_write_b32 v31, v34 offset:2992
    v_pk_fma_f32 v[104:105], v[54:55], v[22:23], v[104:105] op_sel:[1,1,0] op_sel_hi:[0,1,1] neg_lo:[0,1,0]
    v_pk_mul_f32 v[60:61], v[62:63], v[20:21] op_sel:[0,0] op_sel_hi:[1,0]
    v_pk_mul_f32 v[66:67], v[64:65], v[18:19] op_sel:[0,0] op_sel_hi:[1,0]
    v_pk_mul_f32 v[68:69], v[70:71], v[18:19] op_sel:[0,0] op_sel_hi:[1,0]
    v_pk_mul_f32 v[106:107], v[104:105], v[22:23] op_sel:[0,0] op_sel_hi:[1,0]
    v_pk_fma_f32 v[60:61], v[62:63], v[20:21], v[60:61] op_sel:[1,1,0] op_sel_hi:[0,1,1] neg_lo:[0,1,0]
    v_pk_fma_f32 v[66:67], v[64:65], v[18:19], v[66:67] op_sel:[1,1,0] op_sel_hi:[0,1,1] neg_lo:[0,1,0]
    v_pk_fma_f32 v[68:69], v[70:71], v[18:19], v[68:69] op_sel:[1,1,0] op_sel_hi:[0,1,1] neg_lo:[0,1,0]
    v_pk_fma_f32 v[106:107], v[104:105], v[22:23], v[106:107] op_sel:[1,1,0] op_sel_hi:[0,1,1] neg_lo:[0,1,0]
    v_cvt_pk_bf16_f32 v35, v60, -v61
    v_cvt_pk_bf16_f32 v36, v66, v67
    v_cvt_pk_bf16_f32 v34, v68, v69
    v_pk_mul_f32 v[108:109], v[106:107], v[22:23] op_sel:[0,0] op_sel_hi:[1,0]
    ds_write_b32 v28, v35 offset:1088
    ds_write_b32 v31, v36 offset:1360
    ds_write_b32 v31, v34 offset:3264
    v_pk_fma_f32 v[108:109], v[106:107], v[22:23], v[108:109] op_sel:[1,1,0] op_sel_hi:[0,1,1] neg_lo:[0,1,0]
    v_pk_mul_f32 v[62:63], v[60:61], v[20:21] op_sel:[0,0] op_sel_hi:[1,0]
    v_pk_mul_f32 v[64:65], v[66:67], v[18:19] op_sel:[0,0] op_sel_hi:[1,0]
    v_pk_mul_f32 v[70:71], v[68:69], v[18:19] op_sel:[0,0] op_sel_hi:[1,0]
    v_pk_mul_f32 v[110:111], v[108:109], v[22:23] op_sel:[0,0] op_sel_hi:[1,0]
    v_pk_fma_f32 v[62:63], v[60:61], v[20:21], v[62:63] op_sel:[1,1,0] op_sel_hi:[0,1,1] neg_lo:[0,1,0]
    v_pk_fma_f32 v[64:65], v[66:67], v[18:19], v[64:65] op_sel:[1,1,0] op_sel_hi:[0,1,1] neg_lo:[0,1,0]
    v_pk_fma_f32 v[70:71], v[68:69], v[18:19], v[70:71] op_sel:[1,1,0] op_sel_hi:[0,1,1] neg_lo:[0,1,0]
    v_pk_fma_f32 v[110:111], v[108:109], v[22:23], v[110:111] op_sel:[1,1,0] op_sel_hi:[0,1,1] neg_lo:[0,1,0]
    v_cvt_pk_bf16_f32 v35, v62, -v63
    v_cvt_pk_bf16_f32 v36, v64, v65
    v_cvt_pk_bf16_f32 v34, v70, v71
    v_pk_mul_f32 v[112:113], v[110:111], v[22:23] op_sel:[0,0] op_sel_hi:[1,0]
    ds_write_b32 v28, v35 offset:1360
    ds_write_b32 v31, v36 offset:1632
    ds_write_b32 v31, v34 offset:3536
    v_pk_fma_f32 v[112:113], v[110:111], v[22:23], v[112:113] op_sel:[1,1,0] op_sel_hi:[0,1,1] neg_lo:[0,1,0]
    v_pk_mul_f32 v[60:61], v[62:63], v[20:21] op_sel:[0,0] op_sel_hi:[1,0]
    v_pk_mul_f32 v[66:67], v[64:65], v[18:19] op_sel:[0,0] op_sel_hi:[1,0]
    v_pk_mul_f32 v[68:69], v[70:71], v[18:19] op_sel:[0,0] op_sel_hi:[1,0]
    v_pk_mul_f32 v[114:115], v[112:113], v[22:23] op_sel:[0,0] op_sel_hi:[1,0]
    v_pk_fma_f32 v[60:61], v[62:63], v[20:21], v[60:61] op_sel:[1,1,0] op_sel_hi:[0,1,1] neg_lo:[0,1,0]
    v_pk_fma_f32 v[66:67], v[64:65], v[18:19], v[66:67] op_sel:[1,1,0] op_sel_hi:[0,1,1] neg_lo:[0,1,0]
    v_pk_fma_f32 v[68:69], v[70:71], v[18:19], v[68:69] op_sel:[1,1,0] op_sel_hi:[0,1,1] neg_lo:[0,1,0]
    v_pk_fma_f32 v[114:115], v[112:113], v[22:23], v[114:115] op_sel:[1,1,0] op_sel_hi:[0,1,1] neg_lo:[0,1,0]
    v_cvt_pk_bf16_f32 v35, v60, -v61
    v_cvt_pk_bf16_f32 v36, v66, v67
    v_cvt_pk_bf16_f32 v34, v68, v69
    v_pk_mul_f32 v[116:117], v[114:115], v[22:23] op_sel:[0,0] op_sel_hi:[1,0]
    ds_write_b32 v28, v35 offset:1632
    ds_write_b32 v31, v36 offset:1904
    ds_write_b32 v31, v34 offset:3808
    v_pk_fma_f32 v[116:117], v[114:115], v[22:23], v[116:117] op_sel:[1,1,0] op_sel_hi:[0,1,1] neg_lo:[0,1,0]
    v_pk_mul_f32 v[62:63], v[60:61], v[20:21] op_sel:[0,0] op_sel_hi:[1,0]
    v_pk_mul_f32 v[70:71], v[68:69], v[18:19] op_sel:[0,0] op_sel_hi:[1,0]
    v_pk_mul_f32 v[118:119], v[116:117], v[22:23] op_sel:[0,0] op_sel_hi:[1,0]
    v_pk_fma_f32 v[62:63], v[60:61], v[20:21], v[62:63] op_sel:[1,1,0] op_sel_hi:[0,1,1] neg_lo:[0,1,0]
    v_pk_fma_f32 v[70:71], v[68:69], v[18:19], v[70:71] op_sel:[1,1,0] op_sel_hi:[0,1,1] neg_lo:[0,1,0]
    v_pk_fma_f32 v[118:119], v[116:117], v[22:23], v[118:119] op_sel:[1,1,0] op_sel_hi:[0,1,1] neg_lo:[0,1,0]
    v_cvt_pk_bf16_f32 v35, v62, -v63
    v_cvt_pk_bf16_f32 v34, v70, v71
    v_pk_mul_f32 v[120:121], v[118:119], v[22:23] op_sel:[0,0] op_sel_hi:[1,0]
    ds_write_b32 v28, v35 offset:1904
    ds_write_b32 v31, v34 offset:4080
    v_pk_fma_f32 v[120:121], v[118:119], v[22:23], v[120:121] op_sel:[1,1,0] op_sel_hi:[0,1,1] neg_lo:[0,1,0]
    v_pk_mul_f32 v[60:61], v[62:63], v[20:21] op_sel:[0,0] op_sel_hi:[1,0]
    v_pk_fma_f32 v[60:61], v[62:63], v[20:21], v[60:61] op_sel:[1,1,0] op_sel_hi:[0,1,1] neg_lo:[0,1,0]
    v_cvt_pk_bf16_f32 v35, v60, -v61
    ds_write_b32 v28, v35 offset:2176
    v_pk_mul_f32 v[62:63], v[60:61], v[20:21] op_sel:[0,0] op_sel_hi:[1,0]
    v_pk_fma_f32 v[62:63], v[60:61], v[20:21], v[62:63] op_sel:[1,1,0] op_sel_hi:[0,1,1] neg_lo:[0,1,0]
    v_cvt_pk_bf16_f32 v35, v62, -v63
    ds_write_b32 v28, v35 offset:2448
    v_pk_mul_f32 v[60:61], v[62:63], v[20:21] op_sel:[0,0] op_sel_hi:[1,0]
    v_pk_fma_f32 v[60:61], v[62:63], v[20:21], v[60:61] op_sel:[1,1,0] op_sel_hi:[0,1,1] neg_lo:[0,1,0]
    v_cvt_pk_bf16_f32 v35, v60, -v61
    ds_write_b32 v28, v35 offset:2720
    v_pk_mul_f32 v[62:63], v[60:61], v[20:21] op_sel:[0,0] op_sel_hi:[1,0]
    v_pk_fma_f32 v[62:63], v[60:61], v[20:21], v[62:63] op_sel:[1,1,0] op_sel_hi:[0,1,1] neg_lo:[0,1,0]
    v_cvt_pk_bf16_f32 v35, v62, -v63
    ds_write_b32 v28, v35 offset:2992
    v_pk_mul_f32 v[60:61], v[62:63], v[20:21] op_sel:[0,0] op_sel_hi:[1,0]
    v_pk_fma_f32 v[60:61], v[62:63], v[20:21], v[60:61] op_sel:[1,1,0] op_sel_hi:[0,1,1] neg_lo:[0,1,0]
    v_cvt_pk_bf16_f32 v35, v60, -v61
    ds_write_b32 v28, v35 offset:3264
    v_pk_mul_f32 v[62:63], v[60:61], v[20:21] op_sel:[0,0] op_sel_hi:[1,0]
    v_pk_fma_f32 v[62:63], v[60:61], v[20:21], v[62:63] op_sel:[1,1,0] op_sel_hi:[0,1,1] neg_lo:[0,1,0]
    v_cvt_pk_bf16_f32 v35, v62, -v63
    ds_write_b32 v28, v35 offset:3536
    v_pk_mul_f32 v[60:61], v[62:63], v[20:21] op_sel:[0,0] op_sel_hi:[1,0]
    v_pk_fma_f32 v[60:61], v[62:63], v[20:21], v[60:61] op_sel:[1,1,0] op_sel_hi:[0,1,1] neg_lo:[0,1,0]
    v_cvt_pk_bf16_f32 v35, v60, -v61
    ds_write_b32 v28, v35 offset:3808
    v_pk_mul_f32 v[62:63], v[60:61], v[20:21] op_sel:[0,0] op_sel_hi:[1,0]
    v_pk_fma_f32 v[62:63], v[60:61], v[20:21], v[62:63] op_sel:[1,1,0] op_sel_hi:[0,1,1] neg_lo:[0,1,0]
    v_cvt_pk_bf16_f32 v35, v62, -v63
    ds_write_b32 v28, v35 offset:4080
    s_waitcnt lgkmcnt(0)
    ds_read_b128 v[72:75], v29 offset:0
    ds_read_b128 v[76:79], v29 offset:64
    ds_read_b128 v[80:83], v29 offset:128
    ds_read_b128 v[84:87], v29 offset:192
    ds_read_b128 v[88:91], v33 offset:0
    ds_read_b128 v[92:95], v33 offset:64
    ds_read_b128 v[96:99], v33 offset:128
    ds_read_b128 v[100:103], v33 offset:192
    v_cvt_pk_bf16_f32 v34, v44, v45
    v_cvt_pk_bf16_f32 v35, v46, v47
    v_cvt_pk_bf16_f32 v36, v48, v49
    ds_write_b32 v31, v34 offset:4352
    ds_write_b32 v31, v35 offset:5440
    ds_write_b32 v31, v36 offset:6528
    v_pk_mul_f32 v[62:63], v[44:45], v[24:25] op_sel:[0,0] op_sel_hi:[1,0]
    v_pk_mul_f32 v[66:67], v[46:47], v[24:25] op_sel:[0,0] op_sel_hi:[1,0]
    v_pk_mul_f32 v[68:69], v[48:49], v[26:27] op_sel:[0,0] op_sel_hi:[1,0]
    v_pk_fma_f32 v[62:63], v[44:45], v[24:25], v[62:63] op_sel:[1,1,0] op_sel_hi:[0,1,1] neg_lo:[0,1,0]
    v_pk_fma_f32 v[66:67], v[46:47], v[24:25], v[66:67] op_sel:[1,1,0] op_sel_hi:[0,1,1] neg_lo:[0,1,0]
    v_pk_fma_f32 v[68:69], v[48:49], v[26:27], v[68:69] op_sel:[1,1,0] op_sel_hi:[0,1,1] neg_lo:[0,1,0]
    v_cvt_pk_bf16_f32 v34, v62, v63
    v_cvt_pk_bf16_f32 v35, v66, v67
    v_cvt_pk_bf16_f32 v36, v68, v69
    ds_write_b32 v31, v34 offset:4624
    ds_write_b32 v31, v35 offset:5712
    ds_write_b32 v31, v36 offset:6800
    v_pk_mul_f32 v[60:61], v[62:63], v[24:25] op_sel:[0,0] op_sel_hi:[1,0]
    v_pk_mul_f32 v[64:65], v[66:67], v[24:25] op_sel:[0,0] op_sel_hi:[1,0]
    v_cvt_pk_bf16_f32 v36, v50, v51
    v_pk_fma_f32 v[60:61], v[62:63], v[24:25], v[60:61] op_sel:[1,1,0] op_sel_hi:[0,1,1] neg_lo:[0,1,0]
    v_pk_fma_f32 v[64:65], v[66:67], v[24:25], v[64:65] op_sel:[1,1,0] op_sel_hi:[0,1,1] neg_lo:[0,1,0]
    ds_write_b32 v31, v36 offset:7072
    v_cvt_pk_bf16_f32 v34, v60, v61
    v_cvt_pk_bf16_f32 v35, v64, v65
    v_pk_mul_f32 v[70:71], v[50:51], v[26:27] op_sel:[0,0] op_sel_hi:[1,0]
    ds_write_b32 v31, v34 offset:4896
    ds_write_b32 v31, v35 offset:5984
    v_pk_fma_f32 v[70:71], v[50:51], v[26:27], v[70:71] op_sel:[1,1,0] op_sel_hi:[0,1,1] neg_lo:[0,1,0]
    v_pk_mul_f32 v[62:63], v[60:61], v[24:25] op_sel:[0,0] op_sel_hi:[1,0]
    v_pk_mul_f32 v[66:67], v[64:65], v[24:25] op_sel:[0,0] op_sel_hi:[1,0]
    v_cvt_pk_bf16_f32 v36, v70, v71
    v_pk_fma_f32 v[62:63], v[60:61], v[24:25], v[62:63] op_sel:[1,1,0] op_sel_hi:[0,1,1] neg_lo:[0,1,0]
    v_pk_fma_f32 v[66:67], v[64:65], v[24:25], v[66:67] op_sel:[1,1,0] op_sel_hi:[0,1,1] neg_lo:[0,1,0]
    ds_write_b32 v31, v36 offset:7344
    v_cvt_pk_bf16_f32 v34, v62, v63
    v_cvt_pk_bf16_f32 v35, v66, v67
    v_cvt_pk_bf16_f32 v36, v52, v53
    ds_write_b32 v31, v34 offset:5168
    ds_write_b32 v31, v35 offset:6256
    ds_write_b32 v31, v36 offset:7616
    v_pk_mul_f32 v[68:69], v[52:53], v[26:27] op_sel:[0,0] op_sel_hi:[1,0]
    v_pk_fma_f32 v[68:69], v[52:53], v[26:27], v[68:69] op_sel:[1,1,0] op_sel_hi:[0,1,1] neg_lo:[0,1,0]
    v_cvt_pk_bf16_f32 v36, v68, v69
    ds_write_b32 v31, v36 offset:7888
    v_cvt_pk_bf16_f32 v36, v54, v55
    ds_write_b32 v31, v36 offset:8160
    v_pk_mul_f32 v[70:71], v[54:55], v[26:27] op_sel:[0,0] op_sel_hi:[1,0]
    v_pk_fma_f32 v[70:71], v[54:55], v[26:27], v[70:71] op_sel:[1,1,0] op_sel_hi:[0,1,1] neg_lo:[0,1,0]
    v_cvt_pk_bf16_f32 v36, v70, v71
    ds_write_b32 v31, v36 offset:8432
    v_cvt_pk_bf16_f32 v122, v104, v105
    v_cvt_pk_bf16_f32 v123, v106, v107
    v_cvt_pk_bf16_f32 v124, v108, v109
    v_cvt_pk_bf16_f32 v125, v110, v111
    v_cvt_pk_bf16_f32 v126, v112, v113
    v_cvt_pk_bf16_f32 v127, v114, v115
    v_cvt_pk_bf16_f32 v128, v116, v117
    v_cvt_pk_bf16_f32 v129, v118, v119
    v_cvt_pk_bf16_f32 v130, v120, v121
    s_waitcnt lgkmcnt(0)
    ds_write_b32 v28, v122 offset:0
    ds_write_b32 v28, v123 offset:272
    ds_write_b32 v28, v124 offset:544
    ds_write_b32 v28, v125 offset:816
    ds_write_b32 v28, v126 offset:1088
    ds_write_b32 v28, v127 offset:1360
    ds_write_b32 v28, v128 offset:1632
    ds_write_b32 v28, v129 offset:1904
    ds_write_b32 v28, v130 offset:2176
    ds_read_b128 v[148:151], v33 offset:4352
    ds_read_b128 v[152:155], v33 offset:4416
    ds_read_b128 v[156:159], v33 offset:4480
    ds_read_b128 v[160:163], v33 offset:4544
    v_mfma_f32_16x16x32_bf16 v[136:139], v[88:91], v[72:75], 0
    v_mfma_f32_16x16x32_bf16 v[136:139], v[92:95], v[76:79], v[136:139]
    v_mfma_f32_16x16x32_bf16 v[136:139], v[96:99], v[80:83], v[136:139]
    v_mfma_f32_16x16x32_bf16 v[136:139], v[100:103], v[84:87], v[136:139]
    s_waitcnt lgkmcnt(0)
    ds_read_b128 v[88:91], v29 offset:0
    ds_read_b128 v[92:95], v29 offset:64
    ds_read_b128 v[96:99], v29 offset:128
    ds_read_b128 v[100:103], v29 offset:192
    v_mfma_f32_16x16x32_bf16 v[140:143], v[148:151], v[72:75], 0
    v_mfma_f32_16x16x32_bf16 v[140:143], v[152:155], v[76:79], v[140:143]
    v_mfma_f32_16x16x32_bf16 v[140:143], v[156:159], v[80:83], v[140:143]
    v_mfma_f32_16x16x32_bf16 v[140:143], v[160:163], v[84:87], v[140:143]
    s_waitcnt lgkmcnt(0)
    v_mfma_f32_16x16x32_bf16 v[144:147], v[88:91], v[72:75], 0
    v_mfma_f32_16x16x32_bf16 v[144:147], v[92:95], v[76:79], v[144:147]
    v_mfma_f32_16x16x32_bf16 v[144:147], v[96:99], v[80:83], v[144:147]
    v_mfma_f32_16x16x32_bf16 v[144:147], v[100:103], v[84:87], v[144:147]
    s_add_u32 s7, s6, 1
    s_and_b32 s7, s7, 7
    s_mul_i32 s3, s7, 176128
    s_add_u32 s3, s3, s77
    s_add_u32 m0, s79, 40960
    s_nop 0
    buffer_load_dwordx4 v197, s[12:15], s3 offen lds
    s_add_u32 m0, s79, 41984
    s_nop 0
    buffer_load_dwordx4 v198, s[12:15], s3 offen lds
    s_add_u32 m0, s79, 43008
    s_nop 0
    buffer_load_dwordx4 v199, s[12:15], s3 offen lds
    s_add_u32 m0, s79, 53248
    s_nop 0
    buffer_load_dwordx4 v197, s[16:19], s3 offen lds
    s_add_u32 m0, s79, 54272
    s_nop 0
    buffer_load_dwordx4 v198, s[16:19], s3 offen lds
    s_add_u32 m0, s79, 55296
    s_nop 0
    buffer_load_dwordx4 v199, s[16:19], s3 offen lds
    s_lshl_b32 s7, s7, 7
    s_add_u32 s7, s7, s76
    s_add_u32 m0, s78, 40960
    s_add_u32 s53, s7, 0
    buffer_load_dwordx4 v195, s[8:11], s53 offen lds
    s_add_u32 m0, s78, 41984
    s_add_u32 s53, s7, 8192
    buffer_load_dwordx4 v196, s[8:11], s53 offen lds
    s_add_u32 m0, s78, 43008
    s_add_u32 s53, s7, 16384
    buffer_load_dwordx4 v195, s[8:11], s53 offen lds
    s_add_u32 m0, s78, 44032
    s_add_u32 s53, s7, 24576
    buffer_load_dwordx4 v196, s[8:11], s53 offen lds
    s_cmp_eq_u32 s71, 0
    s_cbranch_scc0 SSM_HF1a
    ds_write_b32 v28, v142 offset:0
    v_mov_b32 v220, v136
    ds_write_b32 v28, v143 offset:256
    v_mov_b32 v221, v137
    ds_write_b32 v28, v144 offset:512
    v_mov_b32 v222, v138
    ds_write_b32 v28, v145 offset:768
    v_mov_b32 v223, v139
    ds_write_b32 v28, v146 offset:1024
    v_mov_b32 v224, v140
    ds_write_b32 v28, v147 offset:1280
    v_mov_b32 v225, v141
    s_branch SSM_HFXa
SSM_HF1a:
    ds_write_b32 v28, v136 offset:0
    v_mov_b32 v220, v142
    ds_write_b32 v28, v137 offset:256
    v_mov_b32 v221, v143
    ds_write_b32 v28, v138 offset:512
    v_mov_b32 v222, v144
    ds_write_b32 v28, v139 offset:768
    v_mov_b32 v223, v145
    ds_write_b32 v28, v140 offset:1024
    v_mov_b32 v224, v146
    ds_write_b32 v28, v141 offset:1280
    v_mov_b32 v225, v147
SSM_HFXa:
    s_waitcnt lgkmcnt(0)
    v_and_b32 v3, 15, v1
    v_lshrrev_b32 v4, 4, v1
    v_lshrrev_b32 v5, 2, v3
    v_lshl_add_u32 v5, v4, 3, v5
    v_mul_u32_u24 v5, 192, v5
    v_and_b32 v6, 1, v3
    v_lshl_add_u32 v5, v6, 3, v5
    s_lshr_b32 s53, s45, 1
    s_mul_i32 s53, s53, 12288
    s_add_u32 s53, s53, 16384
    v_add_u32 v5, s53, v5
    v_bfe_u32 v6, v3, 1, 1
    v_and_b32 v7, 1, v4
    v_lshlrev_b32 v7, 1, v7
    s_and_b32 s53, s45, 1
    s_mul_i32 s53, s53, 6
    v_add_u32 v8, s53, v6
    v_add_u32 v8, 0, v8
    v_xor_b32 v8, v8, v7
    v_lshl_add_u32 v16, v8, 4, v5
    v_add_u32 v8, s53, v6
    v_add_u32 v8, 2, v8
    v_xor_b32 v8, v8, v7
    v_lshl_add_u32 v17, v8, 4, v5
    v_add_u32 v8, s53, v6
    v_add_u32 v8, 4, v8
    v_xor_b32 v8, v8, v7
    v_lshl_add_u32 v18, v8, 4, v5
    v_mov_b32 v24, 0x3f803f80
    v_mov_b32 v25, 0x3f803f80
    v_mov_b32 v26, 0x3f803f80
    v_mov_b32 v27, 0x3f803f80
    s_waitcnt vmcnt(10)
    s_setprio 3
    s_barrier
    s_add_u32 s7, s6, 2
    s_and_b32 s7, s7, 7
    s_mul_i32 s3, s7, 176128
    s_add_u32 s3, s3, s77
    s_add_u32 m0, s79, 81920
    s_nop 0
    buffer_load_dwordx4 v197, s[12:15], s3 offen lds
    s_add_u32 m0, s79, 82944
    s_nop 0
    buffer_load_dwordx4 v198, s[12:15], s3 offen lds
    s_add_u32 m0, s79, 83968
    s_nop 0
    buffer_load_dwordx4 v199, s[12:15], s3 offen lds
    s_add_u32 m0, s79, 94208
    s_nop 0
    buffer_load_dwordx4 v197, s[16:19], s3 offen lds
    s_add_u32 m0, s79, 95232
    s_nop 0
    buffer_load_dwordx4 v198, s[16:19], s3 offen lds
    s_add_u32 m0, s79, 96256
    s_nop 0
    buffer_load_dwordx4 v199, s[16:19], s3 offen lds
    s_lshl_b32 s7, s7, 7
    s_add_u32 s7, s7, s76
    s_add_u32 m0, s78, 81920
    s_add_u32 s53, s7, 0
    buffer_load_dwordx4 v195, s[8:11], s53 offen lds
    s_add_u32 m0, s78, 82944
    s_add_u32 s53, s7, 8192
    buffer_load_dwordx4 v196, s[8:11], s53 offen lds
    s_add_u32 m0, s78, 83968
    s_add_u32 s53, s7, 16384
    buffer_load_dwordx4 v195, s[8:11], s53 offen lds
    s_add_u32 m0, s78, 84992
    s_add_u32 s53, s7, 24576
    buffer_load_dwordx4 v196, s[8:11], s53 offen lds
    s_lshl_b32 s53, s45, 8
    s_add_u32 s53, s53, 149600
    v_lshlrev_b32 v64, 1, v1
    v_add_u32 v64, s53, v64
    ds_read_u16 v80, v64 offset:0
    ds_read_u16 v81, v64 offset:1024
    ds_read_u16 v82, v64 offset:2048
    ds_read_u16 v83, v64 offset:3072
    ds_read_u16 v84, v64 offset:4096
    ds_read_u16 v85, v64 offset:5120
    ds_read_u16 v86, v64 offset:6144
    ds_read_u16 v87, v64 offset:7168
    ds_read_u16 v88, v64 offset:128
    ds_read_u16 v89, v64 offset:1152
    ds_read_u16 v90, v64 offset:2176
    ds_read_u16 v91, v64 offset:3200
    ds_read_u16 v92, v64 offset:4224
    ds_read_u16 v93, v64 offset:5248
    ds_read_u16 v94, v64 offset:6272
    ds_read_u16 v95, v64 offset:7296
    v_mov_b32 v65, 157792
    v_and_b32 v66, 7, v1
    v_lshl_add_u32 v65, v66, 3, v65
    ds_read_b64 v[76:77], v65
    s_lshl_b32 s53, s46, 4
    s_add_u32 s53, s53, s47
    s_lshl_b32 s53, s53, 13
    s_lshl_b32 s54, s45, 11
    s_add_u32 s53, s53, s54
    v_lshlrev_b32 v64, 4, v1
    s_waitcnt lgkmcnt(0)
    v_lshl_or_b32 v68, v81, 16, v80
    v_lshl_or_b32 v69, v83, 16, v82
    v_lshl_or_b32 v70, v85, 16, v84
    v_lshl_or_b32 v71, v87, 16, v86
    buffer_store_dwordx4 v[68:71], v64, s[28:31], s53 offen offset:0 sc1
    v_lshl_or_b32 v72, v89, 16, v88
    v_lshl_or_b32 v73, v91, 16, v90
    v_lshl_or_b32 v74, v93, 16, v92
    v_lshl_or_b32 v75, v95, 16, v94
    buffer_store_dwordx4 v[72:75], v64, s[28:31], s53 offen offset:1024 sc1
    s_lshl_b32 s53, s46, 4
    s_add_u32 s53, s53, s47
    s_lshl_b32 s53, s53, 6
    s_add_u32 s53, s53, 16384
    v_lshlrev_b32 v66, 3, v66
    buffer_store_dwordx2 v[76:77], v66, s[40:43], s53 offen sc1
    v_mov_b32 v20, v16
    v_mov_b32 v21, v17
    v_mov_b32 v22, v18
    ds_read_b64_tr_b16 v[40:41], v20 offset:0
    ds_read_b64_tr_b16 v[42:43], v20 offset:768
    ds_read_b64_tr_b16 v[44:45], v21 offset:0
    ds_read_b64_tr_b16 v[46:47], v21 offset:768
    ds_read_b64_tr_b16 v[48:49], v22 offset:0
    ds_read_b64_tr_b16 v[50:51], v22 offset:768
    ds_read_b64_tr_b16 v[52:53], v20 offset:6144
    ds_read_b64_tr_b16 v[54:55], v20 offset:6912
    ds_read_b64_tr_b16 v[56:57], v21 offset:6144
    ds_read_b64_tr_b16 v[58:59], v21 offset:6912
    ds_read_b64_tr_b16 v[60:61], v22 offset:6144
    ds_read_b64_tr_b16 v[62:63], v22 offset:6912
    s_waitcnt lgkmcnt(10)
    v_mfma_f32_16x16x32_bf16 v[28:31], v[40:43], v[24:27], 0
    s_waitcnt lgkmcnt(8)
    v_mfma_f32_16x16x32_bf16 v[32:35], v[44:47], v[24:27], 0
    s_waitcnt lgkmcnt(6)
    v_mfma_f32_16x16x32_bf16 v[36:39], v[48:51], v[24:27], 0
    s_waitcnt lgkmcnt(4)
    v_mfma_f32_16x16x32_bf16 v[28:31], v[52:55], v[24:27], v[28:31]
    s_waitcnt lgkmcnt(2)
    v_mfma_f32_16x16x32_bf16 v[32:35], v[56:59], v[24:27], v[32:35]
    s_waitcnt lgkmcnt(0)
    v_mfma_f32_16x16x32_bf16 v[36:39], v[60:63], v[24:27], v[36:39]
    s_cmp_ge_u32 s46, 8
    s_cbranch_scc1 S_NCSP
    s_lshl_b32 s53, s47, 3
    s_add_u32 s53, s53, s6
    s_mul_i32 s53, s53, 768
    s_mul_i32 s54, s45, 192
    s_add_u32 s53, s53, s54
    s_add_u32 s53, s53, 65536
    v_lshrrev_b32 v64, 4, v1
    v_lshlrev_b32 v64, 4, v64
    s_mov_b32 exec_lo, 0x00010001
    s_mov_b32 exec_hi, 0x00010001
    buffer_store_dwordx4 v[28:31], v64, s[40:43], s53 offen offset:0 sc1
    buffer_store_dwordx4 v[32:35], v64, s[40:43], s53 offen offset:64 sc1
    buffer_store_dwordx4 v[36:39], v64, s[40:43], s53 offen offset:128 sc1
    s_mov_b64 exec, -1
S_NCSP:
    s_waitcnt vmcnt(13)
    s_waitcnt lgkmcnt(0)
    s_barrier
    s_add_u32 s7, s6, 3
    s_and_b32 s7, s7, 7
    s_mul_i32 s3, s7, 176128
    s_add_u32 s3, s3, s77
    s_add_u32 m0, s79, 0
    s_nop 0
    buffer_load_dwordx4 v197, s[12:15], s3 offen lds
    s_add_u32 m0, s79, 1024
    s_nop 0
    buffer_load_dwordx4 v198, s[12:15], s3 offen lds
    s_add_u32 m0, s79, 2048
    s_nop 0
    buffer_load_dwordx4 v199, s[12:15], s3 offen lds
    s_add_u32 m0, s79, 12288
    s_nop 0
    buffer_load_dwordx4 v197, s[16:19], s3 offen lds
    s_add_u32 m0, s79, 13312
    s_nop 0
    buffer_load_dwordx4 v198, s[16:19], s3 offen lds
    s_add_u32 m0, s79, 14336
    s_nop 0
    buffer_load_dwordx4 v199, s[16:19], s3 offen lds
    s_lshl_b32 s7, s7, 7
    s_add_u32 s7, s7, s76
    s_add_u32 m0, s78, 0
    s_add_u32 s53, s7, 0
    buffer_load_dwordx4 v195, s[8:11], s53 offen lds
    s_add_u32 m0, s78, 1024
    s_add_u32 s53, s7, 8192
    buffer_load_dwordx4 v196, s[8:11], s53 offen lds
    s_add_u32 m0, s78, 2048
    s_add_u32 s53, s7, 16384
    buffer_load_dwordx4 v195, s[8:11], s53 offen lds
    s_add_u32 m0, s78, 3072
    s_add_u32 s53, s7, 24576
    buffer_load_dwordx4 v196, s[8:11], s53 offen lds
    v_mov_b32 v240, 143872
    ds_read_b32 v241, v240
    s_waitcnt lgkmcnt(0)
    v_readfirstlane_b32 s49, v241
    ds_read_b32 v232, v219 offset:0
    ds_read_b32 v233, v219 offset:256
    ds_read_b32 v234, v219 offset:512
    ds_read_b32 v235, v219 offset:768
    ds_read_b32 v236, v219 offset:1024
    ds_read_b32 v237, v219 offset:1280
    s_waitcnt lgkmcnt(0)
    v_add_f32 v220, v220, v232
    v_cvt_pk_bf16_f32 v220, v220, v220
    v_add_f32 v221, v221, v233
    v_cvt_pk_bf16_f32 v221, v221, v221
    v_add_f32 v222, v222, v234
    v_cvt_pk_bf16_f32 v222, v222, v222
    v_add_f32 v223, v223, v235
    v_cvt_pk_bf16_f32 v223, v223, v223
    v_add_f32 v224, v224, v236
    v_cvt_pk_bf16_f32 v224, v224, v224
    v_add_f32 v225, v225, v237
    v_cvt_pk_bf16_f32 v225, v225, v225
    ds_write_b16 v226, v220
    ds_write_b16 v227, v221
    ds_write_b16 v228, v222
    ds_write_b16 v229, v223
    ds_write_b16 v230, v224
    ds_write_b16 v231, v225
    s_waitcnt vmcnt(13)
    s_waitcnt lgkmcnt(0)
    s_barrier
    s_add_u32 s7, s6, 4
    s_and_b32 s7, s7, 7
    s_mul_i32 s3, s7, 176128
    s_add_u32 s3, s3, s77
    s_add_u32 m0, s79, 40960
    s_nop 0
    buffer_load_dwordx4 v197, s[12:15], s3 offen lds
    s_add_u32 m0, s79, 41984
    s_nop 0
    buffer_load_dwordx4 v198, s[12:15], s3 offen lds
    s_add_u32 m0, s79, 43008
    s_nop 0
    buffer_load_dwordx4 v199, s[12:15], s3 offen lds
    s_add_u32 m0, s79, 53248
    s_nop 0
    buffer_load_dwordx4 v197, s[16:19], s3 offen lds
    s_add_u32 m0, s79, 54272
    s_nop 0
    buffer_load_dwordx4 v198, s[16:19], s3 offen lds
    s_add_u32 m0, s79, 55296
    s_nop 0
    buffer_load_dwordx4 v199, s[16:19], s3 offen lds
    s_lshl_b32 s7, s7, 7
    s_add_u32 s7, s7, s76
    s_add_u32 m0, s78, 40960
    s_add_u32 s53, s7, 0
    buffer_load_dwordx4 v195, s[8:11], s53 offen lds
    s_add_u32 m0, s78, 41984
    s_add_u32 s53, s7, 8192
    buffer_load_dwordx4 v196, s[8:11], s53 offen lds
    s_add_u32 m0, s78, 43008
    s_add_u32 s53, s7, 16384
    buffer_load_dwordx4 v195, s[8:11], s53 offen lds
    s_add_u32 m0, s78, 44032
    s_add_u32 s53, s7, 24576
    buffer_load_dwordx4 v196, s[8:11], s53 offen lds
    s_lshl_b32 s53, s45, 6
    v_add_u32 v38, s53, v1
    v_lshlrev_b32 v40, 3, v38
    v_sub_u32 v40, 2047, v40
    v_cvt_f32_i32 v40, v40
    v_subrev_f32 v41, 0x3f800000, v40
    v_subrev_f32 v42, 0x40000000, v40
    v_subrev_f32 v43, 0x40400000, v40
    v_subrev_f32 v44, 0x40800000, v40
    v_subrev_f32 v45, 0x40a00000, v40
    v_subrev_f32 v46, 0x40c00000, v40
    v_subrev_f32 v47, 0x40e00000, v40
    v_subrev_f32 v48, 0x41000000, v40
    v_subrev_f32 v49, 0x41100000, v40
    v_subrev_f32 v50, 0x41200000, v40
    v_subrev_f32 v51, 0x41300000, v40
    v_cvt_pk_bf16_f32 v52, |v40|, |v41|
    v_cvt_pk_bf16_f32 v53, |v42|, |v43|
    v_cvt_pk_bf16_f32 v54, |v44|, |v45|
    v_cvt_pk_bf16_f32 v55, |v46|, |v47|
    v_cvt_pk_bf16_f32 v56, |v48|, |v49|
    v_cvt_pk_bf16_f32 v57, |v50|, |v51|
    v_lshlrev_b32_sdwa v60, 2, v52 dst_sel:DWORD dst_unused:UNUSED_PAD src0_sel:DWORD src1_sel:WORD_0
    v_lshlrev_b32_sdwa v61, 2, v52 dst_sel:DWORD dst_unused:UNUSED_PAD src0_sel:DWORD src1_sel:WORD_1
    v_lshlrev_b32_sdwa v62, 2, v53 dst_sel:DWORD dst_unused:UNUSED_PAD src0_sel:DWORD src1_sel:WORD_0
    v_lshlrev_b32_sdwa v63, 2, v53 dst_sel:DWORD dst_unused:UNUSED_PAD src0_sel:DWORD src1_sel:WORD_1
    v_lshlrev_b32_sdwa v64, 2, v54 dst_sel:DWORD dst_unused:UNUSED_PAD src0_sel:DWORD src1_sel:WORD_0
    v_lshlrev_b32_sdwa v65, 2, v54 dst_sel:DWORD dst_unused:UNUSED_PAD src0_sel:DWORD src1_sel:WORD_1
    v_lshlrev_b32_sdwa v66, 2, v55 dst_sel:DWORD dst_unused:UNUSED_PAD src0_sel:DWORD src1_sel:WORD_0
    v_lshlrev_b32_sdwa v67, 2, v55 dst_sel:DWORD dst_unused:UNUSED_PAD src0_sel:DWORD src1_sel:WORD_1
    v_lshlrev_b32_sdwa v68, 2, v56 dst_sel:DWORD dst_unused:UNUSED_PAD src0_sel:DWORD src1_sel:WORD_0
    v_lshlrev_b32_sdwa v69, 2, v56 dst_sel:DWORD dst_unused:UNUSED_PAD src0_sel:DWORD src1_sel:WORD_1
    v_lshlrev_b32_sdwa v70, 2, v57 dst_sel:DWORD dst_unused:UNUSED_PAD src0_sel:DWORD src1_sel:WORD_0
    v_max_u32 v67, 65020, v67
    v_add_u32 v60, 0x13444, v60
    v_add_u32 v61, 0x13444, v61
    v_add_u32 v62, 0x13444, v62
    v_add_u32 v63, 0x13444, v63
    v_add_u32 v64, 0x13444, v64
    v_add_u32 v65, 0x13444, v65
    v_add_u32 v66, 0x13444, v66
    v_add_u32 v67, 0x13444, v67
    v_add_u32 v68, 0x13444, v68
    v_add_u32 v69, 0x13444, v69
    v_add_u32 v70, 0x13444, v70
    ds_read_b32 v72, v60
    ds_read_b32 v73, v61
    ds_read_b32 v74, v62
    ds_read_b32 v75, v63
    ds_read_b32 v76, v64
    ds_read_b32 v77, v65
    ds_read_b32 v78, v66
    ds_read_b32 v79, v67
    ds_read_b32 v80, v68
    ds_read_b32 v81, v69
    ds_read_b32 v82, v70
    v_lshlrev_b32 v71, 4, v38
    v_add_u32 v71, 40960, v71
    s_waitcnt vmcnt(10)
    s_waitcnt lgkmcnt(0)
    s_barrier
    s_add_u32 s7, s6, 5
    s_and_b32 s7, s7, 7
    s_mul_i32 s3, s7, 176128
    s_add_u32 s3, s3, s77
    s_add_u32 m0, s79, 81920
    s_nop 0
    buffer_load_dwordx4 v197, s[12:15], s3 offen lds
    s_add_u32 m0, s79, 82944
    s_nop 0
    buffer_load_dwordx4 v198, s[12:15], s3 offen lds
    s_add_u32 m0, s79, 83968
    s_nop 0
    buffer_load_dwordx4 v199, s[12:15], s3 offen lds
    s_add_u32 m0, s79, 94208
    s_nop 0
    buffer_load_dwordx4 v197, s[16:19], s3 offen lds
    s_add_u32 m0, s79, 95232
    s_nop 0
    buffer_load_dwordx4 v198, s[16:19], s3 offen lds
    s_add_u32 m0, s79, 96256
    s_nop 0
    buffer_load_dwordx4 v199, s[16:19], s3 offen lds
    s_lshl_b32 s7, s7, 7
    s_add_u32 s7, s7, s76
    s_add_u32 m0, s78, 81920
    s_add_u32 s53, s7, 0
    buffer_load_dwordx4 v195, s[8:11], s53 offen lds
    s_add_u32 m0, s78, 82944
    s_add_u32 s53, s7, 8192
    buffer_load_dwordx4 v196, s[8:11], s53 offen lds
    s_add_u32 m0, s78, 83968
    s_add_u32 s53, s7, 16384
    buffer_load_dwordx4 v195, s[8:11], s53 offen lds
    s_add_u32 m0, s78, 84992
    s_add_u32 s53, s7, 24576
    buffer_load_dwordx4 v196, s[8:11], s53 offen lds
    s_cmp_lg_u32 s45, 0
    s_cbranch_scc1 S_NFX
    s_lshl_b32 s53, s46, 4
    s_add_u32 s53, s53, s47
    s_lshl_b32 s53, s53, 2
    s_add_u32 s53, s53, 0
    v_mov_b32 v212, s49
    v_mov_b32 v213, 0
    s_mov_b64 exec, 1
    buffer_store_dword v212, v213, s[40:43], s53 offen sc1
    s_mov_b64 exec, -1
S_NFX:
    v_cmp_ne_u32 vcc, 255, v38
    s_mov_b32 s54, 0x05040100
    s_mov_b32 s55, 0x07060302
    v_cndmask_b32 v80, 0, v80, vcc
    v_cndmask_b32 v81, 0, v81, vcc
    v_cndmask_b32 v82, 0, v82, vcc
    v_perm_b32 v84, v73, v72, s54
    v_perm_b32 v85, v75, v74, s54
    v_perm_b32 v86, v77, v76, s54
    v_perm_b32 v87, v79, v78, s54
    v_perm_b32 v88, v74, v73, s54
    v_perm_b32 v89, v76, v75, s54
    v_perm_b32 v90, v78, v77, s54
    v_perm_b32 v91, v80, v79, s54
    v_perm_b32 v92, v75, v74, s54
    v_perm_b32 v93, v77, v76, s54
    v_perm_b32 v94, v79, v78, s54
    v_perm_b32 v95, v81, v80, s54
    v_perm_b32 v96, v76, v75, s54
    v_perm_b32 v97, v78, v77, s54
    v_perm_b32 v98, v80, v79, s54
    v_perm_b32 v99, v82, v81, s54
    v_perm_b32 v100, v73, v72, s55
    v_perm_b32 v101, v75, v74, s55
    v_perm_b32 v102, v77, v76, s55
    v_perm_b32 v103, v79, v78, s55
    v_perm_b32 v104, v74, v73, s55
    v_perm_b32 v105, v76, v75, s55
    v_perm_b32 v106, v78, v77, s55
    v_perm_b32 v107, v80, v79, s55
    v_perm_b32 v108, v75, v74, s55
    v_perm_b32 v109, v77, v76, s55
    v_perm_b32 v110, v79, v78, s55
    v_perm_b32 v111, v81, v80, s55
    v_perm_b32 v112, v76, v75, s55
    v_perm_b32 v113, v78, v77, s55
    v_perm_b32 v114, v80, v79, s55
    v_perm_b32 v115, v82, v81, s55
    s_waitcnt vmcnt(10)
    s_waitcnt lgkmcnt(0)
    s_barrier
    s_add_u32 s7, s6, 6
    s_and_b32 s7, s7, 7
    s_mul_i32 s3, s7, 176128
    s_add_u32 s3, s3, s77
    s_add_u32 m0, s79, 0
    s_nop 0
    buffer_load_dwordx4 v197, s[12:15], s3 offen lds
    s_add_u32 m0, s79, 1024
    s_nop 0
    buffer_load_dwordx4 v198, s[12:15], s3 offen lds
    s_add_u32 m0, s79, 2048
    s_nop 0
    buffer_load_dwordx4 v199, s[12:15], s3 offen lds
    s_add_u32 m0, s79, 12288
    s_nop 0
    buffer_load_dwordx4 v197, s[16:19], s3 offen lds
    s_add_u32 m0, s79, 13312
    s_nop 0
    buffer_load_dwordx4 v198, s[16:19], s3 offen lds
    s_add_u32 m0, s79, 14336
    s_nop 0
    buffer_load_dwordx4 v199, s[16:19], s3 offen lds
    s_lshl_b32 s7, s7, 7
    s_add_u32 s7, s7, s76
    s_add_u32 m0, s78, 0
    s_add_u32 s53, s7, 0
    buffer_load_dwordx4 v195, s[8:11], s53 offen lds
    s_add_u32 m0, s78, 1024
    s_add_u32 s53, s7, 8192
    buffer_load_dwordx4 v196, s[8:11], s53 offen lds
    s_add_u32 m0, s78, 2048
    s_add_u32 s53, s7, 16384
    buffer_load_dwordx4 v195, s[8:11], s53 offen lds
    s_add_u32 m0, s78, 3072
    s_add_u32 s53, s7, 24576
    buffer_load_dwordx4 v196, s[8:11], s53 offen lds
    v_lshrrev_b32 v116, 3, v1
    v_and_b32 v117, 7, v1
    v_bfe_u32 v118, v116, 1, 2
    v_lshlrev_b32 v118, 1, v118
    v_xor_b32 v117, v117, v118
    v_lshlrev_b32 v116, 10, v116
    v_lshl_add_u32 v194, v117, 4, v116
    s_and_b32 s4, s51, 7
    s_mul_i32 s4, s4, 11
    s_lshr_b32 s4, s4, 3
    s_and_b32 s5, s52, 3
    s_mul_i32 s5, s5, 3
    s_add_u32 s4, s4, s5
    s_cmp_ge_u32 s4, 11
    s_cselect_b32 s5, 11, 0
    s_sub_u32 s4, s4, s5
    s_mul_i32 s66, s45, 11
    s_lshl_b32 s66, s66, 15
    s_lshl_b32 s5, s52, 7
    s_add_u32 s66, s66, s5
    s_lshl_b32 s67, s45, 12
    s_mov_b32 s68, 24576
    s_cmp_lt_u32 s45, 2
    s_cselect_b32 s68, 114688, s68
    s_add_u32 s68, s68, s67
    s_waitcnt vmcnt(10)
    s_waitcnt lgkmcnt(0)
    s_barrier
    s_add_u32 s7, s6, 7
    s_and_b32 s7, s7, 7
    s_mul_i32 s3, s7, 176128
    s_add_u32 s3, s3, s77
    s_add_u32 m0, s79, 40960
    s_nop 0
    buffer_load_dwordx4 v197, s[12:15], s3 offen lds
    s_add_u32 m0, s79, 41984
    s_nop 0
    buffer_load_dwordx4 v198, s[12:15], s3 offen lds
    s_add_u32 m0, s79, 43008
    s_nop 0
    buffer_load_dwordx4 v199, s[12:15], s3 offen lds
    s_add_u32 m0, s79, 53248
    s_nop 0
    buffer_load_dwordx4 v197, s[16:19], s3 offen lds
    s_add_u32 m0, s79, 54272
    s_nop 0
    buffer_load_dwordx4 v198, s[16:19], s3 offen lds
    s_add_u32 m0, s79, 55296
    s_nop 0
    buffer_load_dwordx4 v199, s[16:19], s3 offen lds
    s_lshl_b32 s7, s7, 7
    s_add_u32 s7, s7, s76
    s_add_u32 m0, s78, 40960
    s_add_u32 s53, s7, 0
    buffer_load_dwordx4 v195, s[8:11], s53 offen lds
    s_add_u32 m0, s78, 41984
    s_add_u32 s53, s7, 8192
    buffer_load_dwordx4 v196, s[8:11], s53 offen lds
    s_add_u32 m0, s78, 43008
    s_add_u32 s53, s7, 16384
    buffer_load_dwordx4 v195, s[8:11], s53 offen lds
    s_add_u32 m0, s78, 44032
    s_add_u32 s53, s7, 24576
    buffer_load_dwordx4 v196, s[8:11], s53 offen lds
    v_lshlrev_b32 v240, 4, v1
    buffer_load_dwordx4 v[244:247], v240, s[40:43], 0 offen sc1
    v_and_b32 v232, 15, v1
    s_lshl_b32 s53, s46, 4
    v_add_u32 v232, s53, v232
    v_subrev_u32 v233, 16, v1
    v_lshlrev_b32 v234, 4, v233
    v_add_u32 v234, s47, v234
    v_cmp_gt_u32 vcc, 8, v233
    s_nop 1
    v_cndmask_b32 v232, v232, v234, vcc
    v_lshlrev_b32 v232, 2, v232
    buffer_load_dword v235, v232, s[40:43], 0 offen sc1
    s_waitcnt vmcnt(12)
    s_waitcnt lgkmcnt(0)
    s_barrier
    s_waitcnt vmcnt(2)
    v_mov_b32 v242, 143916
    v_mov_b32 v243, 1
    s_mov_b64 exec, 1
    ds_add_u32 v242, v243
    s_mov_b64 exec, -1
    s_waitcnt vmcnt(0)
    v_xor_b32 v244, s49, v244
    v_xor_b32 v245, s49, v245
    v_xor_b32 v246, s49, v246
    v_xor_b32 v247, s49, v247
    v_or_b32 v244, v244, v245
    v_or_b32 v246, v246, v247
    v_or_b32 v244, v244, v246
    v_cmp_eq_u32 vcc, 0, v244
    s_mov_b32 s74, 0
    s_cmp_eq_u64 vcc, -1
    s_cbranch_scc0 S_NOU
    s_mov_b32 s74, 1
    s_cmp_lg_u32 s45, 1
    s_cbranch_scc1 S_NOU
    s_and_b32 s53, s50, 31
    s_lshl_b32 s53, s53, 16
    s_lshr_b32 s54, s50, 5
    s_lshl_b32 s54, s54, 10
    s_add_u32 s53, s53, s54
    v_lshrrev_b32 v240, 3, v1
    v_lshlrev_b32 v240, 13, v240
    v_and_b32 v241, 7, v1
    v_lshl_add_u32 v240, v241, 7, v240
    buffer_load_dword v206, v240, s[28:31], s53 offen sc1
S_NOU:
    s_mov_b32 s75, 0
    s_cmp_lg_u32 s45, 0
    s_cbranch_scc1 S_NST
    v_cmp_eq_u32 vcc, s49, v235
    s_cmp_eq_u64 vcc, -1
    s_cbranch_scc0 S_NST
    s_mov_b32 s75, 1
    s_lshl_b32 s53, s46, 10
    s_add_u32 s53, s53, 16384
    v_lshlrev_b32 v240, 4, v1
    buffer_load_dwordx4 v[236:239], v240, s[40:43], s53 offen sc1
    v_min_u32 v240, 47, v1
    v_lshlrev_b32 v240, 4, v240
    s_mul_i32 s53, s47, 6144
    s_add_u32 s53, s53, 65536
    buffer_load_dwordx4 v[160:163], v240, s[40:43], s53 offen offset:0 sc1
    buffer_load_dwordx4 v[164:167], v240, s[40:43], s53 offen offset:768 sc1
    buffer_load_dwordx4 v[168:171], v240, s[40:43], s53 offen offset:1536 sc1
    buffer_load_dwordx4 v[172:175], v240, s[40:43], s53 offen offset:2304 sc1
    buffer_load_dwordx4 v[176:179], v240, s[40:43], s53 offen offset:3072 sc1
    s_add_u32 s53, s53, 3840
    buffer_load_dwordx4 v[180:183], v240, s[40:43], s53 offen offset:0 sc1
    buffer_load_dwordx4 v[184:187], v240, s[40:43], s53 offen offset:768 sc1
    buffer_load_dwordx4 v[188:191], v240, s[40:43], s53 offen offset:1536 sc1
    s_waitcnt vmcnt(0)
    v_rcp_f32 v209, v237
    v_rcp_f32 v213, v239
    v_mov_b32 v208, v236
    v_mov_b32 v210, v237
    v_mov_b32 v211, 0
    v_mov_b32 v212, v238
    v_mov_b32 v214, v239
    v_mov_b32 v215, 0
    v_mul_f32 v209, 0xbfb8aa3b, v209
    v_mul_f32 v213, 0xbfb8aa3b, v213
    v_lshlrev_b32 v218, 5, v1
    v_add_u32 v218, 141824, v218
    ds_write_b128 v218, v[208:211]
    ds_write_b128 v218, v[212:215] offset:16
    v_pk_add_f32 v[160:161], v[160:161], v[176:177]
    v_pk_add_f32 v[162:163], v[162:163], v[178:179]
    v_pk_add_f32 v[164:165], v[164:165], v[180:181]
    v_pk_add_f32 v[166:167], v[166:167], v[182:183]
    v_pk_add_f32 v[168:169], v[168:169], v[184:185]
    v_pk_add_f32 v[170:171], v[170:171], v[186:187]
    v_pk_add_f32 v[172:173], v[172:173], v[188:189]
    v_pk_add_f32 v[174:175], v[174:175], v[190:191]
    v_pk_add_f32 v[160:161], v[160:161], v[168:169]
    v_pk_add_f32 v[162:163], v[162:163], v[170:171]
    v_pk_add_f32 v[164:165], v[164:165], v[172:173]
    v_pk_add_f32 v[166:167], v[166:167], v[174:175]
    v_pk_add_f32 v[160:161], v[160:161], v[164:165]
    v_pk_add_f32 v[162:163], v[162:163], v[166:167]
    v_min_u32 v218, 47, v1
    v_lshlrev_b32 v218, 4, v218
    v_add_u32 v218, 140288, v218
    ds_write_b128 v218, v[160:163]
    s_waitcnt lgkmcnt(0)
    v_mov_b32 v218, 143908
    v_mov_b32 v219, 1
    ds_write_b32 v218, v219
    s_mov_b32 s75, 2
S_NST:
    s_add_u32 s5, s4, 0
    s_cmp_ge_u32 s5, 11
    s_cselect_b32 s3, 11, 0
    s_sub_u32 s5, s5, s3
    s_lshl_b32 s5, s5, 15
    s_add_u32 s5, s5, s66
    s_add_u32 m0, s67, 81920
    s_add_u32 s3, s5, 0
    buffer_load_dwordx4 v194, s[20:23], s3 offen lds
    s_add_u32 m0, s67, 82944
    s_add_u32 s3, s5, 8192
    buffer_load_dwordx4 v194, s[20:23], s3 offen lds
    s_add_u32 m0, s67, 83968
    s_add_u32 s3, s5, 16384
    buffer_load_dwordx4 v194, s[20:23], s3 offen lds
    s_add_u32 m0, s67, 84992
    s_add_u32 s3, s5, 24576
    buffer_load_dwordx4 v194, s[20:23], s3 offen lds
    s_add_u32 s5, s4, 1
    s_cmp_ge_u32 s5, 11
    s_cselect_b32 s3, 11, 0
    s_sub_u32 s5, s5, s3
    s_lshl_b32 s5, s5, 15
    s_add_u32 s5, s5, s66
    s_add_u32 m0, s67, 98304
    s_add_u32 s3, s5, 0
    buffer_load_dwordx4 v194, s[20:23], s3 offen lds
    s_add_u32 m0, s67, 99328
    s_add_u32 s3, s5, 8192
    buffer_load_dwordx4 v194, s[20:23], s3 offen lds
    s_add_u32 m0, s67, 100352
    s_add_u32 s3, s5, 16384
    buffer_load_dwordx4 v194, s[20:23], s3 offen lds
    s_add_u32 m0, s67, 101376
    s_add_u32 s3, s5, 24576
    buffer_load_dwordx4 v194, s[20:23], s3 offen lds
    s_cmp_lt_u32 s45, 2
    s_cbranch_scc0 S_S4_lo
    s_add_u32 s5, s4, 4
    s_cmp_ge_u32 s5, 11
    s_cselect_b32 s3, 11, 0
    s_sub_u32 s5, s5, s3
    s_lshl_b32 s5, s5, 15
    s_add_u32 s5, s5, s66
    s_add_u32 m0, s68, 0
    s_add_u32 s3, s5, 0
    buffer_load_dwordx4 v194, s[20:23], s3 offen lds
    s_add_u32 m0, s68, 1024
    s_add_u32 s3, s5, 8192
    buffer_load_dwordx4 v194, s[20:23], s3 offen lds
    s_add_u32 m0, s68, 2048
    s_add_u32 s3, s5, 16384
    buffer_load_dwordx4 v194, s[20:23], s3 offen lds
    s_add_u32 m0, s68, 3072
    s_add_u32 s3, s5, 24576
    buffer_load_dwordx4 v194, s[20:23], s3 offen lds
S_S4_lo:
    s_waitcnt lgkmcnt(0)
    s_cmp_lg_u32 s45, 0
    s_cbranch_scc1 S_NRC
    s_cmp_lg_u32 s75, 1
    s_cbranch_scc1 S_NRC
    s_cmp_lt_u32 s45, 2
    s_waitcnt vmcnt(12)
    v_rcp_f32 v209, v237
    v_rcp_f32 v213, v239
    v_mov_b32 v208, v236
    v_mov_b32 v210, v237
    v_mov_b32 v211, 0
    v_mov_b32 v212, v238
    v_mov_b32 v214, v239
    v_mov_b32 v215, 0
    v_mul_f32 v209, 0xbfb8aa3b, v209
    v_mul_f32 v213, 0xbfb8aa3b, v213
    v_lshlrev_b32 v218, 5, v1
    v_add_u32 v218, 141824, v218
    ds_write_b128 v218, v[208:211]
    ds_write_b128 v218, v[212:215] offset:16
    v_pk_add_f32 v[160:161], v[160:161], v[176:177]
    v_pk_add_f32 v[162:163], v[162:163], v[178:179]
    v_pk_add_f32 v[164:165], v[164:165], v[180:181]
    v_pk_add_f32 v[166:167], v[166:167], v[182:183]
    v_pk_add_f32 v[168:169], v[168:169], v[184:185]
    v_pk_add_f32 v[170:171], v[170:171], v[186:187]
    v_pk_add_f32 v[172:173], v[172:173], v[188:189]
    v_pk_add_f32 v[174:175], v[174:175], v[190:191]
    v_pk_add_f32 v[160:161], v[160:161], v[168:169]
    v_pk_add_f32 v[162:163], v[162:163], v[170:171]
    v_pk_add_f32 v[164:165], v[164:165], v[172:173]
    v_pk_add_f32 v[166:167], v[166:167], v[174:175]
    v_pk_add_f32 v[160:161], v[160:161], v[164:165]
    v_pk_add_f32 v[162:163], v[162:163], v[166:167]
    v_min_u32 v218, 47, v1
    v_lshlrev_b32 v218, 4, v218
    v_add_u32 v218, 140288, v218
    ds_write_b128 v218, v[160:163]
    s_waitcnt lgkmcnt(0)
    v_mov_b32 v218, 143908
    v_mov_b32 v219, 1
    ds_write_b32 v218, v219
S_NRC:
    s_cmp_eq_u32 s74, 0
    s_cbranch_scc1 S_NUG
    s_lshl_b32 s53, s50, 5
    s_lshl_b32 s54, s45, 19
    s_add_u32 s53, s53, s54
    v_lshrrev_b32 v240, 1, v1
    v_lshlrev_b32 v240, 13, v240
    v_and_b32 v241, 1, v1
    v_lshl_add_u32 v240, v241, 4, v240
    buffer_load_dwordx4 v[220:223], v240, s[28:31], s53 offen sc1
    s_add_u32 s53, s53, 262144
    buffer_load_dwordx4 v[224:227], v240, s[28:31], s53 offen sc1
S_NUG:
    v_mov_b32 v242, 143920
    s_mov_b32 s55, 200000
S_CB:
    ds_read_b32 v243, v242
    s_waitcnt lgkmcnt(0)
    v_readfirstlane_b32 s54, v243
    s_cmp_ge_u32 s54, 4
    s_cbranch_scc1 S_CBK
    s_sleep 1
    s_sub_u32 s55, s55, 1
    s_cmp_lg_u32 s55, 0
    s_cbranch_scc1 S_CB
S_CBK:
    s_add_u32 s5, s4, 2
    s_cmp_ge_u32 s5, 11
    s_cselect_b32 s3, 11, 0
    s_sub_u32 s5, s5, s3
    s_lshl_b32 s5, s5, 15
    s_add_u32 s5, s5, s66
    s_add_u32 m0, s67, 0
    s_add_u32 s3, s5, 0
    buffer_load_dwordx4 v194, s[20:23], s3 offen lds
    s_add_u32 m0, s67, 1024
    s_add_u32 s3, s5, 8192
    buffer_load_dwordx4 v194, s[20:23], s3 offen lds
    s_add_u32 m0, s67, 2048
    s_add_u32 s3, s5, 16384
    buffer_load_dwordx4 v194, s[20:23], s3 offen lds
    s_add_u32 m0, s67, 3072
    s_add_u32 s3, s5, 24576
    buffer_load_dwordx4 v194, s[20:23], s3 offen lds
    s_add_u32 s5, s4, 3
    s_cmp_ge_u32 s5, 11
    s_cselect_b32 s3, 11, 0
    s_sub_u32 s5, s5, s3
    s_lshl_b32 s5, s5, 15
    s_add_u32 s5, s5, s66
    s_add_u32 m0, s67, 16384
    s_add_u32 s3, s5, 0
    buffer_load_dwordx4 v194, s[20:23], s3 offen lds
    s_add_u32 m0, s67, 17408
    s_add_u32 s3, s5, 8192
    buffer_load_dwordx4 v194, s[20:23], s3 offen lds
    s_add_u32 m0, s67, 18432
    s_add_u32 s3, s5, 16384
    buffer_load_dwordx4 v194, s[20:23], s3 offen lds
    s_add_u32 m0, s67, 19456
    s_add_u32 s3, s5, 24576
    buffer_load_dwordx4 v194, s[20:23], s3 offen lds
    s_cmp_lt_u32 s45, 2
    s_cbranch_scc1 S_S4_hi
    s_add_u32 s5, s4, 4
    s_cmp_ge_u32 s5, 11
    s_cselect_b32 s3, 11, 0
    s_sub_u32 s5, s5, s3
    s_lshl_b32 s5, s5, 15
    s_add_u32 s5, s5, s66
    s_add_u32 m0, s68, 0
    s_add_u32 s3, s5, 0
    buffer_load_dwordx4 v194, s[20:23], s3 offen lds
    s_add_u32 m0, s68, 1024
    s_add_u32 s3, s5, 8192
    buffer_load_dwordx4 v194, s[20:23], s3 offen lds
    s_add_u32 m0, s68, 2048
    s_add_u32 s3, s5, 16384
    buffer_load_dwordx4 v194, s[20:23], s3 offen lds
    s_add_u32 m0, s68, 3072
    s_add_u32 s3, s5, 24576
    buffer_load_dwordx4 v194, s[20:23], s3 offen lds
S_S4_hi:
    s_waitcnt lgkmcnt(0)
    v_mov_b32 v242, 143924
    s_mov_b32 s55, 200000
S_CC:
    ds_read_b32 v243, v242
    s_waitcnt lgkmcnt(0)
    v_readfirstlane_b32 s54, v243
    s_cmp_ge_u32 s54, 4
    s_cbranch_scc1 S_CCK
    s_sleep 1
    s_sub_u32 s55, s55, 1
    s_cmp_lg_u32 s55, 0
    s_cbranch_scc1 S_CC
S_CCK:
    s_setprio 2
    v_mov_b32 v250, 143876
    v_mov_b32 v253, 1
    v_readfirstlane_b32 s73, v205
    s_lshl_b32 s76, s73, 16
    s_and_b32 s77, s73, 0xffff0000
    s_cmp_eq_u32 s70, 0
    s_cselect_b32 s73, s76, s77
    s_cmp_lg_u32 s45, 0
    s_cbranch_scc1 S_COK
    s_cmp_lg_u32 s75, 0
    s_cbranch_scc1 S_COK
    v_and_b32 v232, 15, v1
    s_lshl_b32 s53, s46, 4
    v_add_u32 v232, s53, v232
    v_subrev_u32 v233, 16, v1
    v_lshlrev_b32 v234, 4, v233
    v_add_u32 v234, s47, v234
    v_cmp_gt_u32 vcc, 8, v233
    s_nop 1
    v_cndmask_b32 v232, v232, v234, vcc
    v_lshlrev_b32 v232, 2, v232
    s_mov_b32 s53, 200000
POLL2:
    buffer_load_dword v244, v232, s[40:43], 0 offen sc1
    s_waitcnt vmcnt(0)
    v_cmp_eq_u32 vcc, s49, v244
    s_cmp_eq_u64 vcc, -1
    s_cbranch_scc1 POLL2_OK
    s_sleep 1
    s_sub_u32 s53, s53, 1
    s_cmp_lg_u32 s53, 0
    s_cbranch_scc1 POLL2
    v_mov_b32 v244, 4
    v_mov_b32 v245, 0
    global_store_dword v245, v244, s[80:81] offset:4
POLL2_OK:
    s_lshl_b32 s53, s46, 10
    s_add_u32 s53, s53, 16384
    v_lshlrev_b32 v240, 4, v1
    buffer_load_dwordx4 v[236:239], v240, s[40:43], s53 offen sc1
    v_min_u32 v240, 47, v1
    v_lshlrev_b32 v240, 4, v240
    s_mul_i32 s53, s47, 6144
    s_add_u32 s53, s53, 65536
    buffer_load_dwordx4 v[160:163], v240, s[40:43], s53 offen offset:0 sc1
    buffer_load_dwordx4 v[164:167], v240, s[40:43], s53 offen offset:768 sc1
    buffer_load_dwordx4 v[168:171], v240, s[40:43], s53 offen offset:1536 sc1
    buffer_load_dwordx4 v[172:175], v240, s[40:43], s53 offen offset:2304 sc1
    buffer_load_dwordx4 v[176:179], v240, s[40:43], s53 offen offset:3072 sc1
    s_add_u32 s53, s53, 3840
    buffer_load_dwordx4 v[180:183], v240, s[40:43], s53 offen offset:0 sc1
    buffer_load_dwordx4 v[184:187], v240, s[40:43], s53 offen offset:768 sc1
    buffer_load_dwordx4 v[188:191], v240, s[40:43], s53 offen offset:1536 sc1
    s_waitcnt vmcnt(0)
    v_rcp_f32 v209, v237
    v_rcp_f32 v213, v239
    v_mov_b32 v208, v236
    v_mov_b32 v210, v237
    v_mov_b32 v211, 0
    v_mov_b32 v212, v238
    v_mov_b32 v214, v239
    v_mov_b32 v215, 0
    v_mul_f32 v209, 0xbfb8aa3b, v209
    v_mul_f32 v213, 0xbfb8aa3b, v213
    v_lshlrev_b32 v218, 5, v1
    v_add_u32 v218, 141824, v218
    ds_write_b128 v218, v[208:211]
    ds_write_b128 v218, v[212:215] offset:16
    v_pk_add_f32 v[160:161], v[160:161], v[176:177]
    v_pk_add_f32 v[162:163], v[162:163], v[178:179]
    v_pk_add_f32 v[164:165], v[164:165], v[180:181]
    v_pk_add_f32 v[166:167], v[166:167], v[182:183]
    v_pk_add_f32 v[168:169], v[168:169], v[184:185]
    v_pk_add_f32 v[170:171], v[170:171], v[186:187]
    v_pk_add_f32 v[172:173], v[172:173], v[188:189]
    v_pk_add_f32 v[174:175], v[174:175], v[190:191]
    v_pk_add_f32 v[160:161], v[160:161], v[168:169]
    v_pk_add_f32 v[162:163], v[162:163], v[170:171]
    v_pk_add_f32 v[164:165], v[164:165], v[172:173]
    v_pk_add_f32 v[166:167], v[166:167], v[174:175]
    v_pk_add_f32 v[160:161], v[160:161], v[164:165]
    v_pk_add_f32 v[162:163], v[162:163], v[166:167]
    v_min_u32 v218, 47, v1
    v_lshlrev_b32 v218, 4, v218
    v_add_u32 v218, 140288, v218
    ds_write_b128 v218, v[160:163]
    s_waitcnt lgkmcnt(0)
    v_mov_b32 v218, 143908
    v_mov_b32 v219, 1
    ds_write_b32 v218, v219
S_COK:
    s_cmp_lg_u32 s74, 0
    s_cbranch_scc1 S_UOK
    v_lshlrev_b32 v240, 4, v1
    s_mov_b32 s53, 200000
POLL3:
    buffer_load_dwordx4 v[244:247], v240, s[40:43], 0 offen sc1
    s_waitcnt vmcnt(0)
    v_xor_b32 v244, s49, v244
    v_xor_b32 v245, s49, v245
    v_xor_b32 v246, s49, v246
    v_xor_b32 v247, s49, v247
    v_or_b32 v244, v244, v245
    v_or_b32 v246, v246, v247
    v_or_b32 v244, v244, v246
    v_cmp_eq_u32 vcc, 0, v244
    s_cmp_eq_u64 vcc, -1
    s_cbranch_scc1 POLL3_OK
    s_sleep 1
    s_sub_u32 s53, s53, 1
    s_cmp_lg_u32 s53, 0
    s_cbranch_scc1 POLL3
    v_mov_b32 v244, 5
    v_mov_b32 v245, 0
    global_store_dword v245, v244, s[80:81] offset:4
POLL3_OK:
    s_lshl_b32 s53, s50, 5
    s_lshl_b32 s54, s45, 19
    s_add_u32 s53, s53, s54
    v_lshrrev_b32 v240, 1, v1
    v_lshlrev_b32 v240, 13, v240
    v_and_b32 v241, 1, v1
    v_lshl_add_u32 v240, v241, 4, v240
    buffer_load_dwordx4 v[220:223], v240, s[28:31], s53 offen sc1
    s_add_u32 s53, s53, 262144
    buffer_load_dwordx4 v[224:227], v240, s[28:31], s53 offen sc1
S_UOK:
    ds_write_b128 v71, v[84:87] offset:0
    ds_write_b128 v71, v[88:91] offset:4160
    ds_write_b128 v71, v[92:95] offset:8320
    ds_write_b128 v71, v[96:99] offset:12480
    ds_write_b128 v71, v[100:103] offset:16640
    ds_write_b128 v71, v[104:107] offset:20800
    ds_write_b128 v71, v[108:111] offset:24960
    ds_write_b128 v71, v[112:115] offset:29120
    s_cmp_lg_u32 s45, 1
    s_cbranch_scc1 SSM_NZ1
    v_mov_b32 v12, 0
    v_mov_b32 v13, 0
    v_mov_b32 v14, 0
    v_mov_b32 v15, 0
    v_bfe_u32 v9, v1, 3, 1
    v_mul_u32_u24 v9, 16640, v9
    v_bfe_u32 v10, v1, 1, 2
    v_mul_u32_u24 v10, 4160, v10
    v_add_u32 v9, v9, v10
    v_and_b32 v10, 1, v1
    v_lshl_add_u32 v9, v10, 4, v9
    v_add_u32 v9, 45056, v9
    ds_write_b128 v9, v[12:15]
SSM_NZ1:
    s_waitcnt vmcnt(0)
    s_lshl_b32 s53, s45, 2
    s_add_u32 s53, s53, 143888
    v_mov_b32 v251, s53
    ds_write_b32 v251, v253
    s_lshl_b32 s53, s45, 10
    s_add_u32 s53, s53, 150112
    v_and_b32 v39, 1, v1
    v_mul_u32_u24 v39, 4608, v39
    v_lshrrev_b32 v38, 1, v1
    v_lshl_add_u32 v39, v38, 4, v39
    v_add_u32 v39, s53, v39
    ds_write_b128 v39, v[220:223]
    ds_write_b128 v39, v[224:227] offset:512
    s_mul_i32 s53, s70, 4608
    s_add_u32 s53, s53, 150112
    v_lshlrev_b32 v39, 4, v1
    v_add_u32 v39, s53, v39
    s_cmp_lg_u32 s71, 0
    s_cbranch_scc1 SSM_NZ0
    v_mov_b32 v12, 0
    v_mov_b32 v13, 0
    v_mov_b32 v14, 0
    v_mov_b32 v15, 0
    v_subrev_u32 v39, 512, v39
    s_mov_b32 exec_hi, 0
    ds_write_b128 v39, v[12:15]
    s_mov_b64 exec, -1
SSM_NZ0:
    s_waitcnt lgkmcnt(0)
    s_mov_b64 exec, 1
    ds_add_u32 v250, v253
    s_mov_b64 exec, -1
    s_mov_b32 s53, 200000
SBAR4:
    ds_read_b32 v252, v250
    s_waitcnt lgkmcnt(0)
    v_readfirstlane_b32 s54, v252
    s_cmp_ge_u32 s54, 4
    s_cbranch_scc1 SBAR4_OK
    s_sleep 1
    s_sub_u32 s53, s53, 1
    s_cmp_lg_u32 s53, 0
    s_cbranch_scc1 SBAR4
SBAR4_OK:
    v_and_b32 v41, 15, v1
    v_lshrrev_b32 v42, 4, v1
    v_sub_u32 v43, 3, v41
    v_and_b32 v43, 3, v43
    v_mul_u32_u24 v40, 4158, v43
    v_lshlrev_b32 v44, 1, v41
    v_sub_u32 v40, v40, v44
    v_lshl_add_u32 v40, v42, 4, v40
    s_mul_i32 s53, s70, 16640
    s_add_u32 s53, s53, 40990
    v_add_u32 v40, s53, v40
    v_lshlrev_b32 v45, 5, v41
    v_lshl_add_u32 v45, v42, 4, v45
    s_mul_i32 s53, s70, 4608
    s_add_u32 s53, s53, 149632
    v_add_u32 v45, s53, v45
    v_lshlrev_b32 v164, 5, v41
    v_lshl_add_u32 v164, v42, 3, v164
    s_lshl_b32 s53, s50, 1
    s_add_u32 s53, s53, s70
    s_lshl_b32 s76, s53, 12
    s_mul_i32 s53, s70, 4608
    s_add_u32 s53, s53, 150112
    v_add_u32 v165, s53, v164
    s_cmp_eq_u32 s71, 0
    s_cbranch_scc0 SSM_CV1
    ds_read_b64 v[184:185], v165 offset:0
    ds_read_b64 v[186:187], v165 offset:1536
    ds_read_b64 v[188:189], v165 offset:2048
    ds_read_b64 v[190:191], v165 offset:3584
    ds_read_b64 v[144:145], v40 offset:4032
    ds_read_b64 v[146:147], v40 offset:4040
    ds_read_b64 v[148:149], v40 offset:3520
    ds_read_b64 v[150:151], v40 offset:3528
    ds_read_b128 v[80:83], v45 offset:448
    ds_read_b128 v[84:87], v45 offset:960
    ds_read_b128 v[88:91], v45 offset:1472
    ds_read_b128 v[92:95], v45 offset:1984
    ds_read_b128 v[96:99], v45 offset:2496
    ds_read_b128 v[100:103], v45 offset:3008
    ds_read_b128 v[104:107], v45 offset:3520
    ds_read_b128 v[108:111], v45 offset:4032
    ds_read_b64 v[152:153], v40 offset:3008
    ds_read_b64 v[154:155], v40 offset:3016
    s_waitcnt lgkmcnt(14)
    v_lshlrev_b32 v168, 16, v184
    v_and_b32 v169, 0xffff0000, v184
    v_mul_f32 v168, s73, v168
    v_mul_f32 v169, s73, v169
    v_cvt_pk_bf16_f32 v184, v168, v169
    v_lshlrev_b32 v168, 16, v184
    v_and_b32 v169, 0xffff0000, v184
    v_lshlrev_b32 v170, 16, v185
    v_and_b32 v171, 0xffff0000, v185
    v_mul_f32 v170, s73, v170
    v_mul_f32 v171, s73, v171
    v_cvt_pk_bf16_f32 v185, v170, v171
    v_lshlrev_b32 v170, 16, v185
    v_and_b32 v171, 0xffff0000, v185
    v_lshlrev_b32 v172, 16, v186
    v_and_b32 v173, 0xffff0000, v186
    v_mul_f32 v172, s73, v172
    v_mul_f32 v173, s73, v173
    v_cvt_pk_bf16_f32 v186, v172, v173
    v_lshlrev_b32 v172, 16, v186
    v_and_b32 v173, 0xffff0000, v186
    v_lshlrev_b32 v174, 16, v187
    v_and_b32 v175, 0xffff0000, v187
    v_mul_f32 v174, s73, v174
    v_mul_f32 v175, s73, v175
    v_cvt_pk_bf16_f32 v187, v174, v175
    v_lshlrev_b32 v174, 16, v187
    v_and_b32 v175, 0xffff0000, v187
    v_lshlrev_b32 v176, 16, v188
    v_and_b32 v177, 0xffff0000, v188
    v_mul_f32 v176, s73, v176
    v_mul_f32 v177, s73, v177
    v_cvt_pk_bf16_f32 v188, v176, v177
    v_lshlrev_b32 v176, 16, v188
    v_and_b32 v177, 0xffff0000, v188
    v_lshlrev_b32 v178, 16, v189
    v_and_b32 v179, 0xffff0000, v189
    v_mul_f32 v178, s73, v178
    v_mul_f32 v179, s73, v179
    v_cvt_pk_bf16_f32 v189, v178, v179
    v_lshlrev_b32 v178, 16, v189
    v_and_b32 v179, 0xffff0000, v189
    v_lshlrev_b32 v180, 16, v190
    v_and_b32 v181, 0xffff0000, v190
    v_mul_f32 v180, s73, v180
    v_mul_f32 v181, s73, v181
    v_cvt_pk_bf16_f32 v190, v180, v181
    v_lshlrev_b32 v180, 16, v190
    v_and_b32 v181, 0xffff0000, v190
    v_lshlrev_b32 v182, 16, v191
    v_and_b32 v183, 0xffff0000, v191
    v_mul_f32 v182, s73, v182
    v_mul_f32 v183, s73, v183
    v_cvt_pk_bf16_f32 v191, v182, v183
    v_lshlrev_b32 v182, 16, v191
    v_and_b32 v183, 0xffff0000, v191
    ds_read_b64 v[156:157], v40 offset:2496
    ds_read_b64 v[158:159], v40 offset:2504
    s_waitcnt lgkmcnt(11)
    v_mfma_f32_16x16x32_bf16 v[48:51], v[144:147], v[80:83], 0
    s_waitcnt lgkmcnt(8)
    v_mfma_f32_16x16x32_bf16 v[52:55], v[144:147], v[92:95], 0
    s_waitcnt lgkmcnt(7)
    v_mfma_f32_16x16x32_bf16 v[56:59], v[144:147], v[96:99], 0
    s_waitcnt lgkmcnt(4)
    v_mfma_f32_16x16x32_bf16 v[60:63], v[144:147], v[108:111], 0
    ds_read_b64 v[144:145], v40 offset:1984
    ds_read_b64 v[146:147], v40 offset:1992
    ds_read_b128 v[112:115], v45 offset:384
    ds_read_b128 v[116:119], v45 offset:896
    ds_read_b128 v[120:123], v45 offset:1408
    ds_read_b128 v[124:127], v45 offset:1920
    ds_read_b128 v[128:131], v45 offset:2432
    ds_read_b128 v[132:135], v45 offset:2944
    ds_read_b128 v[136:139], v45 offset:3456
    ds_read_b128 v[140:143], v45 offset:3968
    v_mfma_f32_16x16x32_bf16 v[52:55], v[148:151], v[88:91], v[52:55]
    v_mfma_f32_16x16x32_bf16 v[56:59], v[148:151], v[92:95], v[56:59]
    v_mfma_f32_16x16x32_bf16 v[60:63], v[148:151], v[104:107], v[60:63]
    ds_read_b64 v[148:149], v40 offset:1472
    ds_read_b64 v[150:151], v40 offset:1480
    s_waitcnt lgkmcnt(14)
    v_mfma_f32_16x16x32_bf16 v[52:55], v[152:155], v[84:87], v[52:55]
    v_mfma_f32_16x16x32_bf16 v[56:59], v[152:155], v[88:91], v[56:59]
    v_mfma_f32_16x16x32_bf16 v[60:63], v[152:155], v[100:103], v[60:63]
    ds_read_b64 v[152:153], v40 offset:960
    ds_read_b64 v[154:155], v40 offset:968
    s_waitcnt lgkmcnt(14)
    v_mfma_f32_16x16x32_bf16 v[52:55], v[156:159], v[80:83], v[52:55]
    v_mfma_f32_16x16x32_bf16 v[56:59], v[156:159], v[84:87], v[56:59]
    v_mfma_f32_16x16x32_bf16 v[60:63], v[156:159], v[96:99], v[60:63]
    ds_read_b64 v[156:157], v40 offset:448
    ds_read_b64 v[158:159], v40 offset:456
    s_waitcnt lgkmcnt(14)
    v_mfma_f32_16x16x32_bf16 v[56:59], v[144:147], v[80:83], v[56:59]
    v_mfma_f32_16x16x32_bf16 v[60:63], v[144:147], v[92:95], v[60:63]
    ds_read_b64 v[144:145], v40 offset:3968
    ds_read_b64 v[146:147], v40 offset:3976
    s_waitcnt lgkmcnt(6)
    v_mfma_f32_16x16x32_bf16 v[60:63], v[148:151], v[88:91], v[60:63]
    ds_read_b64 v[148:149], v40 offset:3456
    ds_read_b64 v[150:151], v40 offset:3464
    s_waitcnt lgkmcnt(6)
    v_mfma_f32_16x16x32_bf16 v[60:63], v[152:155], v[84:87], v[60:63]
    ds_read_b64 v[152:153], v40 offset:2944
    ds_read_b64 v[154:155], v40 offset:2952
    s_waitcnt lgkmcnt(6)
    v_mfma_f32_16x16x32_bf16 v[60:63], v[156:159], v[80:83], v[60:63]
    ds_read_b64 v[156:157], v40 offset:2432
    ds_read_b64 v[158:159], v40 offset:2440
    s_waitcnt lgkmcnt(6)
    v_mfma_f32_16x16x32_bf16 v[48:51], v[144:147], v[112:115], v[48:51]
    v_mfma_f32_16x16x32_bf16 v[52:55], v[144:147], v[124:127], v[52:55]
    v_mfma_f32_16x16x32_bf16 v[56:59], v[144:147], v[128:131], v[56:59]
    v_mfma_f32_16x16x32_bf16 v[60:63], v[144:147], v[140:143], v[60:63]
    ds_read_b64 v[144:145], v40 offset:1920
    ds_read_b64 v[146:147], v40 offset:1928
    ds_read_b128 v[80:83], v45 offset:320
    ds_read_b128 v[84:87], v45 offset:832
    ds_read_b128 v[88:91], v45 offset:1344
    ds_read_b128 v[92:95], v45 offset:1856
    ds_read_b128 v[96:99], v45 offset:2368
    ds_read_b128 v[100:103], v45 offset:2880
    ds_read_b128 v[104:107], v45 offset:3392
    ds_read_b128 v[108:111], v45 offset:3904
    s_waitcnt lgkmcnt(14)
    v_mfma_f32_16x16x32_bf16 v[52:55], v[148:151], v[120:123], v[52:55]
    v_mfma_f32_16x16x32_bf16 v[56:59], v[148:151], v[124:127], v[56:59]
    v_mfma_f32_16x16x32_bf16 v[60:63], v[148:151], v[136:139], v[60:63]
    ds_read_b64 v[148:149], v40 offset:1408
    ds_read_b64 v[150:151], v40 offset:1416
    s_waitcnt lgkmcnt(14)
    v_mfma_f32_16x16x32_bf16 v[52:55], v[152:155], v[116:119], v[52:55]
    v_mfma_f32_16x16x32_bf16 v[56:59], v[152:155], v[120:123], v[56:59]
    v_mfma_f32_16x16x32_bf16 v[60:63], v[152:155], v[132:135], v[60:63]
    ds_read_b64 v[152:153], v40 offset:896
    ds_read_b64 v[154:155], v40 offset:904
    s_waitcnt lgkmcnt(14)
    v_mfma_f32_16x16x32_bf16 v[52:55], v[156:159], v[112:115], v[52:55]
    v_mfma_f32_16x16x32_bf16 v[56:59], v[156:159], v[116:119], v[56:59]
    v_mfma_f32_16x16x32_bf16 v[60:63], v[156:159], v[128:131], v[60:63]
    ds_read_b64 v[156:157], v40 offset:384
    ds_read_b64 v[158:159], v40 offset:392
    s_waitcnt lgkmcnt(14)
    v_mfma_f32_16x16x32_bf16 v[56:59], v[144:147], v[112:115], v[56:59]
    v_mfma_f32_16x16x32_bf16 v[60:63], v[144:147], v[124:127], v[60:63]
    ds_read_b64 v[144:145], v40 offset:3904
    ds_read_b64 v[146:147], v40 offset:3912
    s_waitcnt lgkmcnt(6)
    v_mfma_f32_16x16x32_bf16 v[60:63], v[148:151], v[120:123], v[60:63]
    ds_read_b64 v[148:149], v40 offset:3392
    ds_read_b64 v[150:151], v40 offset:3400
    s_waitcnt lgkmcnt(6)
    v_mfma_f32_16x16x32_bf16 v[60:63], v[152:155], v[116:119], v[60:63]
    ds_read_b64 v[152:153], v40 offset:2880
    ds_read_b64 v[154:155], v40 offset:2888
    s_waitcnt lgkmcnt(6)
    v_mfma_f32_16x16x32_bf16 v[60:63], v[156:159], v[112:115], v[60:63]
    ds_read_b64 v[156:157], v40 offset:2368
    ds_read_b64 v[158:159], v40 offset:2376
    s_waitcnt lgkmcnt(6)
    v_mfma_f32_16x16x32_bf16 v[48:51], v[144:147], v[80:83], v[48:51]
    v_mfma_f32_16x16x32_bf16 v[52:55], v[144:147], v[92:95], v[52:55]
    v_mfma_f32_16x16x32_bf16 v[56:59], v[144:147], v[96:99], v[56:59]
    v_mfma_f32_16x16x32_bf16 v[60:63], v[144:147], v[108:111], v[60:63]
    ds_read_b64 v[144:145], v40 offset:1856
    ds_read_b64 v[146:147], v40 offset:1864
    ds_read_b128 v[112:115], v45 offset:256
    ds_read_b128 v[116:119], v45 offset:768
    ds_read_b128 v[120:123], v45 offset:1280
    ds_read_b128 v[124:127], v45 offset:1792
    ds_read_b128 v[128:131], v45 offset:2304
    ds_read_b128 v[132:135], v45 offset:2816
    ds_read_b128 v[136:139], v45 offset:3328
    ds_read_b128 v[140:143], v45 offset:3840
    s_waitcnt lgkmcnt(14)
    v_mfma_f32_16x16x32_bf16 v[52:55], v[148:151], v[88:91], v[52:55]
    v_mfma_f32_16x16x32_bf16 v[56:59], v[148:151], v[92:95], v[56:59]
    v_mfma_f32_16x16x32_bf16 v[60:63], v[148:151], v[104:107], v[60:63]
    ds_read_b64 v[148:149], v40 offset:1344
    ds_read_b64 v[150:151], v40 offset:1352
    s_waitcnt lgkmcnt(14)
    v_mfma_f32_16x16x32_bf16 v[52:55], v[152:155], v[84:87], v[52:55]
    v_mfma_f32_16x16x32_bf16 v[56:59], v[152:155], v[88:91], v[56:59]
    v_mfma_f32_16x16x32_bf16 v[60:63], v[152:155], v[100:103], v[60:63]
    ds_read_b64 v[152:153], v40 offset:832
    ds_read_b64 v[154:155], v40 offset:840
    s_waitcnt lgkmcnt(14)
    v_mfma_f32_16x16x32_bf16 v[52:55], v[156:159], v[80:83], v[52:55]
    v_mfma_f32_16x16x32_bf16 v[56:59], v[156:159], v[84:87], v[56:59]
    v_mfma_f32_16x16x32_bf16 v[60:63], v[156:159], v[96:99], v[60:63]
    ds_read_b64 v[156:157], v40 offset:320
    ds_read_b64 v[158:159], v40 offset:328
    s_waitcnt lgkmcnt(14)
    v_mfma_f32_16x16x32_bf16 v[56:59], v[144:147], v[80:83], v[56:59]
    v_mfma_f32_16x16x32_bf16 v[60:63], v[144:147], v[92:95], v[60:63]
    ds_read_b64 v[144:145], v40 offset:3840
    ds_read_b64 v[146:147], v40 offset:3848
    s_waitcnt lgkmcnt(6)
    v_mfma_f32_16x16x32_bf16 v[60:63], v[148:151], v[88:91], v[60:63]
    ds_read_b64 v[148:149], v40 offset:3328
    ds_read_b64 v[150:151], v40 offset:3336
    s_waitcnt lgkmcnt(6)
    v_mfma_f32_16x16x32_bf16 v[60:63], v[152:155], v[84:87], v[60:63]
    ds_read_b64 v[152:153], v40 offset:2816
    ds_read_b64 v[154:155], v40 offset:2824
    s_waitcnt lgkmcnt(6)
    v_mfma_f32_16x16x32_bf16 v[60:63], v[156:159], v[80:83], v[60:63]
    ds_read_b64 v[156:157], v40 offset:2304
    ds_read_b64 v[158:159], v40 offset:2312
    s_waitcnt lgkmcnt(6)
    v_mfma_f32_16x16x32_bf16 v[48:51], v[144:147], v[112:115], v[48:51]
    v_mfma_f32_16x16x32_bf16 v[52:55], v[144:147], v[124:127], v[52:55]
    v_mfma_f32_16x16x32_bf16 v[56:59], v[144:147], v[128:131], v[56:59]
    v_mfma_f32_16x16x32_bf16 v[60:63], v[144:147], v[140:143], v[60:63]
    ds_read_b64 v[144:145], v40 offset:1792
    ds_read_b64 v[146:147], v40 offset:1800
    ds_read_b128 v[80:83], v45 offset:192
    ds_read_b128 v[84:87], v45 offset:704
    ds_read_b128 v[88:91], v45 offset:1216
    ds_read_b128 v[92:95], v45 offset:1728
    ds_read_b128 v[96:99], v45 offset:2240
    ds_read_b128 v[100:103], v45 offset:2752
    ds_read_b128 v[104:107], v45 offset:3264
    ds_read_b128 v[108:111], v45 offset:3776
    s_waitcnt lgkmcnt(14)
    v_mfma_f32_16x16x32_bf16 v[52:55], v[148:151], v[120:123], v[52:55]
    v_mfma_f32_16x16x32_bf16 v[56:59], v[148:151], v[124:127], v[56:59]
    v_mfma_f32_16x16x32_bf16 v[60:63], v[148:151], v[136:139], v[60:63]
    ds_read_b64 v[148:149], v40 offset:1280
    ds_read_b64 v[150:151], v40 offset:1288
    s_waitcnt lgkmcnt(14)
    v_mfma_f32_16x16x32_bf16 v[52:55], v[152:155], v[116:119], v[52:55]
    v_mfma_f32_16x16x32_bf16 v[56:59], v[152:155], v[120:123], v[56:59]
    v_mfma_f32_16x16x32_bf16 v[60:63], v[152:155], v[132:135], v[60:63]
    ds_read_b64 v[152:153], v40 offset:768
    ds_read_b64 v[154:155], v40 offset:776
    s_waitcnt lgkmcnt(14)
    v_mfma_f32_16x16x32_bf16 v[52:55], v[156:159], v[112:115], v[52:55]
    v_mfma_f32_16x16x32_bf16 v[56:59], v[156:159], v[116:119], v[56:59]
    v_mfma_f32_16x16x32_bf16 v[60:63], v[156:159], v[128:131], v[60:63]
    ds_read_b64 v[156:157], v40 offset:256
    ds_read_b64 v[158:159], v40 offset:264
    s_waitcnt lgkmcnt(14)
    v_mfma_f32_16x16x32_bf16 v[56:59], v[144:147], v[112:115], v[56:59]
    v_mfma_f32_16x16x32_bf16 v[60:63], v[144:147], v[124:127], v[60:63]
    ds_read_b64 v[144:145], v40 offset:3776
    ds_read_b64 v[146:147], v40 offset:3784
    s_waitcnt lgkmcnt(6)
    v_mfma_f32_16x16x32_bf16 v[60:63], v[148:151], v[120:123], v[60:63]
    ds_read_b64 v[148:149], v40 offset:3264
    ds_read_b64 v[150:151], v40 offset:3272
    s_waitcnt lgkmcnt(6)
    v_mfma_f32_16x16x32_bf16 v[60:63], v[152:155], v[116:119], v[60:63]
    ds_read_b64 v[152:153], v40 offset:2752
    ds_read_b64 v[154:155], v40 offset:2760
    s_waitcnt lgkmcnt(6)
    v_mfma_f32_16x16x32_bf16 v[60:63], v[156:159], v[112:115], v[60:63]
    ds_read_b64 v[156:157], v40 offset:2240
    ds_read_b64 v[158:159], v40 offset:2248
    s_waitcnt lgkmcnt(6)
    v_mfma_f32_16x16x32_bf16 v[48:51], v[144:147], v[80:83], v[48:51]
    v_mfma_f32_16x16x32_bf16 v[52:55], v[144:147], v[92:95], v[52:55]
    v_mfma_f32_16x16x32_bf16 v[56:59], v[144:147], v[96:99], v[56:59]
    v_mfma_f32_16x16x32_bf16 v[60:63], v[144:147], v[108:111], v[60:63]
    ds_read_b64 v[144:145], v40 offset:1728
    ds_read_b64 v[146:147], v40 offset:1736
    ds_read_b128 v[112:115], v45 offset:128
    ds_read_b128 v[116:119], v45 offset:640
    ds_read_b128 v[120:123], v45 offset:1152
    ds_read_b128 v[124:127], v45 offset:1664
    ds_read_b128 v[128:131], v45 offset:2176
    ds_read_b128 v[132:135], v45 offset:2688
    ds_read_b128 v[136:139], v45 offset:3200
    ds_read_b128 v[140:143], v45 offset:3712
    s_waitcnt lgkmcnt(14)
    v_mfma_f32_16x16x32_bf16 v[52:55], v[148:151], v[88:91], v[52:55]
    v_mfma_f32_16x16x32_bf16 v[56:59], v[148:151], v[92:95], v[56:59]
    v_mfma_f32_16x16x32_bf16 v[60:63], v[148:151], v[104:107], v[60:63]
    ds_read_b64 v[148:149], v40 offset:1216
    ds_read_b64 v[150:151], v40 offset:1224
    s_waitcnt lgkmcnt(14)
    v_mfma_f32_16x16x32_bf16 v[52:55], v[152:155], v[84:87], v[52:55]
    v_mfma_f32_16x16x32_bf16 v[56:59], v[152:155], v[88:91], v[56:59]
    v_mfma_f32_16x16x32_bf16 v[60:63], v[152:155], v[100:103], v[60:63]
    ds_read_b64 v[152:153], v40 offset:704
    ds_read_b64 v[154:155], v40 offset:712
    s_waitcnt lgkmcnt(14)
    v_mfma_f32_16x16x32_bf16 v[52:55], v[156:159], v[80:83], v[52:55]
    v_mfma_f32_16x16x32_bf16 v[56:59], v[156:159], v[84:87], v[56:59]
    v_mfma_f32_16x16x32_bf16 v[60:63], v[156:159], v[96:99], v[60:63]
    ds_read_b64 v[156:157], v40 offset:192
    ds_read_b64 v[158:159], v40 offset:200
    s_waitcnt lgkmcnt(14)
    v_mfma_f32_16x16x32_bf16 v[56:59], v[144:147], v[80:83], v[56:59]
    v_mfma_f32_16x16x32_bf16 v[60:63], v[144:147], v[92:95], v[60:63]
    ds_read_b64 v[144:145], v40 offset:3712
    ds_read_b64 v[146:147], v40 offset:3720
    s_waitcnt lgkmcnt(6)
    v_mfma_f32_16x16x32_bf16 v[60:63], v[148:151], v[88:91], v[60:63]
    ds_read_b64 v[148:149], v40 offset:3200
    ds_read_b64 v[150:151], v40 offset:3208
    s_waitcnt lgkmcnt(6)
    v_mfma_f32_16x16x32_bf16 v[60:63], v[152:155], v[84:87], v[60:63]
    ds_read_b64 v[152:153], v40 offset:2688
    ds_read_b64 v[154:155], v40 offset:2696
    s_waitcnt lgkmcnt(6)
    v_mfma_f32_16x16x32_bf16 v[60:63], v[156:159], v[80:83], v[60:63]
    ds_read_b64 v[156:157], v40 offset:2176
    ds_read_b64 v[158:159], v40 offset:2184
    s_waitcnt lgkmcnt(6)
    v_mfma_f32_16x16x32_bf16 v[48:51], v[144:147], v[112:115], v[48:51]
    v_mfma_f32_16x16x32_bf16 v[52:55], v[144:147], v[124:127], v[52:55]
    v_mfma_f32_16x16x32_bf16 v[56:59], v[144:147], v[128:131], v[56:59]
    v_mfma_f32_16x16x32_bf16 v[60:63], v[144:147], v[140:143], v[60:63]
    ds_read_b64 v[144:145], v40 offset:1664
    ds_read_b64 v[146:147], v40 offset:1672
    ds_read_b128 v[80:83], v45 offset:64
    ds_read_b128 v[84:87], v45 offset:576
    ds_read_b128 v[88:91], v45 offset:1088
    ds_read_b128 v[92:95], v45 offset:1600
    ds_read_b128 v[96:99], v45 offset:2112
    ds_read_b128 v[100:103], v45 offset:2624
    ds_read_b128 v[104:107], v45 offset:3136
    ds_read_b128 v[108:111], v45 offset:3648
    s_waitcnt lgkmcnt(14)
    v_mfma_f32_16x16x32_bf16 v[52:55], v[148:151], v[120:123], v[52:55]
    v_mfma_f32_16x16x32_bf16 v[56:59], v[148:151], v[124:127], v[56:59]
    v_mfma_f32_16x16x32_bf16 v[60:63], v[148:151], v[136:139], v[60:63]
    ds_read_b64 v[148:149], v40 offset:1152
    ds_read_b64 v[150:151], v40 offset:1160
    s_waitcnt lgkmcnt(14)
    v_mfma_f32_16x16x32_bf16 v[52:55], v[152:155], v[116:119], v[52:55]
    v_mfma_f32_16x16x32_bf16 v[56:59], v[152:155], v[120:123], v[56:59]
    v_mfma_f32_16x16x32_bf16 v[60:63], v[152:155], v[132:135], v[60:63]
    ds_read_b64 v[152:153], v40 offset:640
    ds_read_b64 v[154:155], v40 offset:648
    s_waitcnt lgkmcnt(14)
    v_mfma_f32_16x16x32_bf16 v[52:55], v[156:159], v[112:115], v[52:55]
    v_mfma_f32_16x16x32_bf16 v[56:59], v[156:159], v[116:119], v[56:59]
    v_mfma_f32_16x16x32_bf16 v[60:63], v[156:159], v[128:131], v[60:63]
    ds_read_b64 v[156:157], v40 offset:128
    ds_read_b64 v[158:159], v40 offset:136
    s_waitcnt lgkmcnt(14)
    v_mfma_f32_16x16x32_bf16 v[56:59], v[144:147], v[112:115], v[56:59]
    v_mfma_f32_16x16x32_bf16 v[60:63], v[144:147], v[124:127], v[60:63]
    ds_read_b64 v[144:145], v40 offset:3648
    ds_read_b64 v[146:147], v40 offset:3656
    s_waitcnt lgkmcnt(6)
    v_mfma_f32_16x16x32_bf16 v[60:63], v[148:151], v[120:123], v[60:63]
    ds_read_b64 v[148:149], v40 offset:3136
    ds_read_b64 v[150:151], v40 offset:3144
    s_waitcnt lgkmcnt(6)
    v_mfma_f32_16x16x32_bf16 v[60:63], v[152:155], v[116:119], v[60:63]
    ds_read_b64 v[152:153], v40 offset:2624
    ds_read_b64 v[154:155], v40 offset:2632
    s_waitcnt lgkmcnt(6)
    v_mfma_f32_16x16x32_bf16 v[60:63], v[156:159], v[112:115], v[60:63]
    ds_read_b64 v[156:157], v40 offset:2112
    ds_read_b64 v[158:159], v40 offset:2120
    s_waitcnt lgkmcnt(6)
    v_mfma_f32_16x16x32_bf16 v[48:51], v[144:147], v[80:83], v[48:51]
    v_mfma_f32_16x16x32_bf16 v[52:55], v[144:147], v[92:95], v[52:55]
    v_mfma_f32_16x16x32_bf16 v[56:59], v[144:147], v[96:99], v[56:59]
    v_mfma_f32_16x16x32_bf16 v[60:63], v[144:147], v[108:111], v[60:63]
    ds_read_b64 v[144:145], v40 offset:1600
    ds_read_b64 v[146:147], v40 offset:1608
    ds_read_b128 v[112:115], v45 offset:0
    ds_read_b128 v[116:119], v45 offset:512
    ds_read_b128 v[120:123], v45 offset:1024
    ds_read_b128 v[124:127], v45 offset:1536
    ds_read_b128 v[128:131], v45 offset:2048
    ds_read_b128 v[132:135], v45 offset:2560
    ds_read_b128 v[136:139], v45 offset:3072
    ds_read_b128 v[140:143], v45 offset:3584
    s_waitcnt lgkmcnt(14)
    v_mfma_f32_16x16x32_bf16 v[52:55], v[148:151], v[88:91], v[52:55]
    v_mfma_f32_16x16x32_bf16 v[56:59], v[148:151], v[92:95], v[56:59]
    v_mfma_f32_16x16x32_bf16 v[60:63], v[148:151], v[104:107], v[60:63]
    ds_read_b64 v[148:149], v40 offset:1088
    ds_read_b64 v[150:151], v40 offset:1096
    s_waitcnt lgkmcnt(14)
    v_mfma_f32_16x16x32_bf16 v[52:55], v[152:155], v[84:87], v[52:55]
    v_mfma_f32_16x16x32_bf16 v[56:59], v[152:155], v[88:91], v[56:59]
    v_mfma_f32_16x16x32_bf16 v[60:63], v[152:155], v[100:103], v[60:63]
    ds_read_b64 v[152:153], v40 offset:576
    ds_read_b64 v[154:155], v40 offset:584
    s_waitcnt lgkmcnt(14)
    v_mfma_f32_16x16x32_bf16 v[52:55], v[156:159], v[80:83], v[52:55]
    v_mfma_f32_16x16x32_bf16 v[56:59], v[156:159], v[84:87], v[56:59]
    v_mfma_f32_16x16x32_bf16 v[60:63], v[156:159], v[96:99], v[60:63]
    ds_read_b64 v[156:157], v40 offset:64
    ds_read_b64 v[158:159], v40 offset:72
    s_waitcnt lgkmcnt(14)
    v_mfma_f32_16x16x32_bf16 v[56:59], v[144:147], v[80:83], v[56:59]
    v_mfma_f32_16x16x32_bf16 v[60:63], v[144:147], v[92:95], v[60:63]
    ds_read_b64 v[144:145], v40 offset:3584
    ds_read_b64 v[146:147], v40 offset:3592
    s_waitcnt lgkmcnt(6)
    v_mfma_f32_16x16x32_bf16 v[60:63], v[148:151], v[88:91], v[60:63]
    ds_read_b64 v[148:149], v40 offset:3072
    ds_read_b64 v[150:151], v40 offset:3080
    s_waitcnt lgkmcnt(6)
    v_mfma_f32_16x16x32_bf16 v[60:63], v[152:155], v[84:87], v[60:63]
    ds_read_b64 v[152:153], v40 offset:2560
    ds_read_b64 v[154:155], v40 offset:2568
    s_waitcnt lgkmcnt(6)
    v_mfma_f32_16x16x32_bf16 v[60:63], v[156:159], v[80:83], v[60:63]
    ds_read_b64 v[156:157], v40 offset:2048
    ds_read_b64 v[158:159], v40 offset:2056
    s_waitcnt lgkmcnt(6)
    v_mfma_f32_16x16x32_bf16 v[48:51], v[144:147], v[112:115], v[48:51]
    v_mfma_f32_16x16x32_bf16 v[52:55], v[144:147], v[124:127], v[52:55]
    v_mfma_f32_16x16x32_bf16 v[56:59], v[144:147], v[128:131], v[56:59]
    v_mfma_f32_16x16x32_bf16 v[60:63], v[144:147], v[140:143], v[60:63]
    ds_read_b64 v[144:145], v40 offset:1536
    ds_read_b64 v[146:147], v40 offset:1544
    s_waitcnt lgkmcnt(6)
    v_mfma_f32_16x16x32_bf16 v[52:55], v[148:151], v[120:123], v[52:55]
    v_mfma_f32_16x16x32_bf16 v[56:59], v[148:151], v[124:127], v[56:59]
    v_mfma_f32_16x16x32_bf16 v[60:63], v[148:151], v[136:139], v[60:63]
    ds_read_b64 v[148:149], v40 offset:1024
    ds_read_b64 v[150:151], v40 offset:1032
    s_waitcnt lgkmcnt(6)
    v_mfma_f32_16x16x32_bf16 v[52:55], v[152:155], v[116:119], v[52:55]
    v_mfma_f32_16x16x32_bf16 v[56:59], v[152:155], v[120:123], v[56:59]
    v_mfma_f32_16x16x32_bf16 v[60:63], v[152:155], v[132:135], v[60:63]
    ds_read_b64 v[152:153], v40 offset:512
    ds_read_b64 v[154:155], v40 offset:520
    s_waitcnt lgkmcnt(6)
    v_mfma_f32_16x16x32_bf16 v[52:55], v[156:159], v[112:115], v[52:55]
    v_mfma_f32_16x16x32_bf16 v[56:59], v[156:159], v[116:119], v[56:59]
    v_mfma_f32_16x16x32_bf16 v[60:63], v[156:159], v[128:131], v[60:63]
    ds_read_b64 v[156:157], v40 offset:0
    ds_read_b64 v[158:159], v40 offset:8
    s_waitcnt lgkmcnt(6)
    v_mfma_f32_16x16x32_bf16 v[56:59], v[144:147], v[112:115], v[56:59]
    v_mfma_f32_16x16x32_bf16 v[60:63], v[144:147], v[124:127], v[60:63]
    s_waitcnt lgkmcnt(4)
    v_mfma_f32_16x16x32_bf16 v[60:63], v[148:151], v[120:123], v[60:63]
    s_waitcnt lgkmcnt(2)
    v_mfma_f32_16x16x32_bf16 v[60:63], v[152:155], v[116:119], v[60:63]
    s_waitcnt lgkmcnt(0)
    v_mfma_f32_16x16x32_bf16 v[60:63], v[156:159], v[112:115], v[60:63]
    v_cvt_pk_bf16_f32 v192, v48, v49
    v_cvt_pk_bf16_f32 v193, v50, v51
    v_lshlrev_b32 v48, 16, v192
    v_and_b32 v49, 0xffff0000, v192
    v_lshlrev_b32 v50, 16, v193
    v_and_b32 v51, 0xffff0000, v193
    v_pk_add_f32 v[48:49], v[48:49], v[168:169]
    v_pk_add_f32 v[50:51], v[50:51], v[170:171]
    v_cvt_pk_bf16_f32 v184, v48, v49
    v_cvt_pk_bf16_f32 v185, v50, v51
    buffer_store_dwordx2 v[184:185], v164, s[32:35], s76 offen offset:0 sc1
    v_cvt_pk_bf16_f32 v192, v52, v53
    v_cvt_pk_bf16_f32 v193, v54, v55
    v_lshlrev_b32 v52, 16, v192
    v_and_b32 v53, 0xffff0000, v192
    v_lshlrev_b32 v54, 16, v193
    v_and_b32 v55, 0xffff0000, v193
    v_pk_add_f32 v[52:53], v[52:53], v[172:173]
    v_pk_add_f32 v[54:55], v[54:55], v[174:175]
    v_cvt_pk_bf16_f32 v186, v52, v53
    v_cvt_pk_bf16_f32 v187, v54, v55
    buffer_store_dwordx2 v[186:187], v164, s[32:35], s76 offen offset:1536 sc1
    v_cvt_pk_bf16_f32 v192, v56, v57
    v_cvt_pk_bf16_f32 v193, v58, v59
    v_lshlrev_b32 v56, 16, v192
    v_and_b32 v57, 0xffff0000, v192
    v_lshlrev_b32 v58, 16, v193
    v_and_b32 v59, 0xffff0000, v193
    v_pk_add_f32 v[56:57], v[56:57], v[176:177]
    v_pk_add_f32 v[58:59], v[58:59], v[178:179]
    v_cvt_pk_bf16_f32 v188, v56, v57
    v_cvt_pk_bf16_f32 v189, v58, v59
    buffer_store_dwordx2 v[188:189], v164, s[32:35], s76 offen offset:2048 sc1
    v_cvt_pk_bf16_f32 v192, v60, v61
    v_cvt_pk_bf16_f32 v193, v62, v63
    v_lshlrev_b32 v60, 16, v192
    v_and_b32 v61, 0xffff0000, v192
    v_lshlrev_b32 v62, 16, v193
    v_and_b32 v63, 0xffff0000, v193
    v_pk_add_f32 v[60:61], v[60:61], v[180:181]
    v_pk_add_f32 v[62:63], v[62:63], v[182:183]
    v_cvt_pk_bf16_f32 v190, v60, v61
    v_cvt_pk_bf16_f32 v191, v62, v63
    buffer_store_dwordx2 v[190:191], v164, s[32:35], s76 offen offset:3584 sc1
    s_branch SSM_CVX
SSM_CV1:
    ds_read_b64 v[184:185], v165 offset:512
    ds_read_b64 v[186:187], v165 offset:1024
    ds_read_b64 v[188:189], v165 offset:2560
    ds_read_b64 v[190:191], v165 offset:3072
    ds_read_b64 v[144:145], v40 offset:4032
    ds_read_b64 v[146:147], v40 offset:4040
    ds_read_b64 v[148:149], v40 offset:3520
    ds_read_b64 v[150:151], v40 offset:3528
    ds_read_b128 v[80:83], v45 offset:448
    ds_read_b128 v[84:87], v45 offset:960
    ds_read_b128 v[88:91], v45 offset:1472
    ds_read_b128 v[92:95], v45 offset:1984
    ds_read_b128 v[96:99], v45 offset:2496
    ds_read_b128 v[100:103], v45 offset:3008
    ds_read_b128 v[104:107], v45 offset:3520
    ds_read_b64 v[152:153], v40 offset:3008
    ds_read_b64 v[154:155], v40 offset:3016
    s_waitcnt lgkmcnt(13)
    v_lshlrev_b32 v168, 16, v184
    v_and_b32 v169, 0xffff0000, v184
    v_mul_f32 v168, s73, v168
    v_mul_f32 v169, s73, v169
    v_cvt_pk_bf16_f32 v184, v168, v169
    v_lshlrev_b32 v168, 16, v184
    v_and_b32 v169, 0xffff0000, v184
    v_lshlrev_b32 v170, 16, v185
    v_and_b32 v171, 0xffff0000, v185
    v_mul_f32 v170, s73, v170
    v_mul_f32 v171, s73, v171
    v_cvt_pk_bf16_f32 v185, v170, v171
    v_lshlrev_b32 v170, 16, v185
    v_and_b32 v171, 0xffff0000, v185
    v_lshlrev_b32 v172, 16, v186
    v_and_b32 v173, 0xffff0000, v186
    v_mul_f32 v172, s73, v172
    v_mul_f32 v173, s73, v173
    v_cvt_pk_bf16_f32 v186, v172, v173
    v_lshlrev_b32 v172, 16, v186
    v_and_b32 v173, 0xffff0000, v186
    v_lshlrev_b32 v174, 16, v187
    v_and_b32 v175, 0xffff0000, v187
    v_mul_f32 v174, s73, v174
    v_mul_f32 v175, s73, v175
    v_cvt_pk_bf16_f32 v187, v174, v175
    v_lshlrev_b32 v174, 16, v187
    v_and_b32 v175, 0xffff0000, v187
    v_lshlrev_b32 v176, 16, v188
    v_and_b32 v177, 0xffff0000, v188
    v_mul_f32 v176, s73, v176
    v_mul_f32 v177, s73, v177
    v_cvt_pk_bf16_f32 v188, v176, v177
    v_lshlrev_b32 v176, 16, v188
    v_and_b32 v177, 0xffff0000, v188
    v_lshlrev_b32 v178, 16, v189
    v_and_b32 v179, 0xffff0000, v189
    v_mul_f32 v178, s73, v178
    v_mul_f32 v179, s73, v179
    v_cvt_pk_bf16_f32 v189, v178, v179
    v_lshlrev_b32 v178, 16, v189
    v_and_b32 v179, 0xffff0000, v189
    v_lshlrev_b32 v180, 16, v190
    v_and_b32 v181, 0xffff0000, v190
    v_mul_f32 v180, s73, v180
    v_mul_f32 v181, s73, v181
    v_cvt_pk_bf16_f32 v190, v180, v181
    v_lshlrev_b32 v180, 16, v190
    v_and_b32 v181, 0xffff0000, v190
    v_lshlrev_b32 v182, 16, v191
    v_and_b32 v183, 0xffff0000, v191
    v_mul_f32 v182, s73, v182
    v_mul_f32 v183, s73, v183
    v_cvt_pk_bf16_f32 v191, v182, v183
    v_lshlrev_b32 v182, 16, v191
    v_and_b32 v183, 0xffff0000, v191
    ds_read_b64 v[156:157], v40 offset:2496
    ds_read_b64 v[158:159], v40 offset:2504
    s_waitcnt lgkmcnt(9)
    v_mfma_f32_16x16x32_bf16 v[48:51], v[144:147], v[84:87], 0
    s_waitcnt lgkmcnt(8)
    v_mfma_f32_16x16x32_bf16 v[52:55], v[144:147], v[88:91], 0
    s_waitcnt lgkmcnt(5)
    v_mfma_f32_16x16x32_bf16 v[56:59], v[144:147], v[100:103], 0
    s_waitcnt lgkmcnt(4)
    v_mfma_f32_16x16x32_bf16 v[60:63], v[144:147], v[104:107], 0
    ds_read_b64 v[144:145], v40 offset:1984
    ds_read_b64 v[146:147], v40 offset:1992
    ds_read_b128 v[112:115], v45 offset:384
    ds_read_b128 v[116:119], v45 offset:896
    ds_read_b128 v[120:123], v45 offset:1408
    ds_read_b128 v[124:127], v45 offset:1920
    ds_read_b128 v[128:131], v45 offset:2432
    ds_read_b128 v[132:135], v45 offset:2944
    ds_read_b128 v[136:139], v45 offset:3456
    v_mfma_f32_16x16x32_bf16 v[48:51], v[148:151], v[80:83], v[48:51]
    v_mfma_f32_16x16x32_bf16 v[52:55], v[148:151], v[84:87], v[52:55]
    v_mfma_f32_16x16x32_bf16 v[56:59], v[148:151], v[96:99], v[56:59]
    v_mfma_f32_16x16x32_bf16 v[60:63], v[148:151], v[100:103], v[60:63]
    ds_read_b64 v[148:149], v40 offset:1472
    ds_read_b64 v[150:151], v40 offset:1480
    s_waitcnt lgkmcnt(13)
    v_mfma_f32_16x16x32_bf16 v[52:55], v[152:155], v[80:83], v[52:55]
    v_mfma_f32_16x16x32_bf16 v[56:59], v[152:155], v[92:95], v[56:59]
    v_mfma_f32_16x16x32_bf16 v[60:63], v[152:155], v[96:99], v[60:63]
    ds_read_b64 v[152:153], v40 offset:960
    ds_read_b64 v[154:155], v40 offset:968
    s_waitcnt lgkmcnt(13)
    v_mfma_f32_16x16x32_bf16 v[56:59], v[156:159], v[88:91], v[56:59]
    v_mfma_f32_16x16x32_bf16 v[60:63], v[156:159], v[92:95], v[60:63]
    ds_read_b64 v[156:157], v40 offset:3968
    ds_read_b64 v[158:159], v40 offset:3976
    s_waitcnt lgkmcnt(13)
    v_mfma_f32_16x16x32_bf16 v[56:59], v[144:147], v[84:87], v[56:59]
    v_mfma_f32_16x16x32_bf16 v[60:63], v[144:147], v[88:91], v[60:63]
    ds_read_b64 v[144:145], v40 offset:3456
    ds_read_b64 v[146:147], v40 offset:3464
    s_waitcnt lgkmcnt(6)
    v_mfma_f32_16x16x32_bf16 v[56:59], v[148:151], v[80:83], v[56:59]
    v_mfma_f32_16x16x32_bf16 v[60:63], v[148:151], v[84:87], v[60:63]
    ds_read_b64 v[148:149], v40 offset:2944
    ds_read_b64 v[150:151], v40 offset:2952
    s_waitcnt lgkmcnt(6)
    v_mfma_f32_16x16x32_bf16 v[60:63], v[152:155], v[80:83], v[60:63]
    ds_read_b64 v[152:153], v40 offset:2432
    ds_read_b64 v[154:155], v40 offset:2440
    s_waitcnt lgkmcnt(6)
    v_mfma_f32_16x16x32_bf16 v[48:51], v[156:159], v[116:119], v[48:51]
    v_mfma_f32_16x16x32_bf16 v[52:55], v[156:159], v[120:123], v[52:55]
    v_mfma_f32_16x16x32_bf16 v[56:59], v[156:159], v[132:135], v[56:59]
    v_mfma_f32_16x16x32_bf16 v[60:63], v[156:159], v[136:139], v[60:63]
    ds_read_b64 v[156:157], v40 offset:1920
    ds_read_b64 v[158:159], v40 offset:1928
    ds_read_b128 v[80:83], v45 offset:320
    ds_read_b128 v[84:87], v45 offset:832
    ds_read_b128 v[88:91], v45 offset:1344
    ds_read_b128 v[92:95], v45 offset:1856
    ds_read_b128 v[96:99], v45 offset:2368
    ds_read_b128 v[100:103], v45 offset:2880
    ds_read_b128 v[104:107], v45 offset:3392
    s_waitcnt lgkmcnt(13)
    v_mfma_f32_16x16x32_bf16 v[48:51], v[144:147], v[112:115], v[48:51]
    v_mfma_f32_16x16x32_bf16 v[52:55], v[144:147], v[116:119], v[52:55]
    v_mfma_f32_16x16x32_bf16 v[56:59], v[144:147], v[128:131], v[56:59]
    v_mfma_f32_16x16x32_bf16 v[60:63], v[144:147], v[132:135], v[60:63]
    ds_read_b64 v[144:145], v40 offset:1408
    ds_read_b64 v[146:147], v40 offset:1416
    s_waitcnt lgkmcnt(13)
    v_mfma_f32_16x16x32_bf16 v[52:55], v[148:151], v[112:115], v[52:55]
    v_mfma_f32_16x16x32_bf16 v[56:59], v[148:151], v[124:127], v[56:59]
    v_mfma_f32_16x16x32_bf16 v[60:63], v[148:151], v[128:131], v[60:63]
    ds_read_b64 v[148:149], v40 offset:896
    ds_read_b64 v[150:151], v40 offset:904
    s_waitcnt lgkmcnt(13)
    v_mfma_f32_16x16x32_bf16 v[56:59], v[152:155], v[120:123], v[56:59]
    v_mfma_f32_16x16x32_bf16 v[60:63], v[152:155], v[124:127], v[60:63]
    ds_read_b64 v[152:153], v40 offset:3904
    ds_read_b64 v[154:155], v40 offset:3912
    s_waitcnt lgkmcnt(13)
    v_mfma_f32_16x16x32_bf16 v[56:59], v[156:159], v[116:119], v[56:59]
    v_mfma_f32_16x16x32_bf16 v[60:63], v[156:159], v[120:123], v[60:63]
    ds_read_b64 v[156:157], v40 offset:3392
    ds_read_b64 v[158:159], v40 offset:3400
    s_waitcnt lgkmcnt(6)
    v_mfma_f32_16x16x32_bf16 v[56:59], v[144:147], v[112:115], v[56:59]
    v_mfma_f32_16x16x32_bf16 v[60:63], v[144:147], v[116:119], v[60:63]
    ds_read_b64 v[144:145], v40 offset:2880
    ds_read_b64 v[146:147], v40 offset:2888
    s_waitcnt lgkmcnt(6)
    v_mfma_f32_16x16x32_bf16 v[60:63], v[148:151], v[112:115], v[60:63]
    ds_read_b64 v[148:149], v40 offset:2368
    ds_read_b64 v[150:151], v40 offset:2376
    s_waitcnt lgkmcnt(6)
    v_mfma_f32_16x16x32_bf16 v[48:51], v[152:155], v[84:87], v[48:51]
    v_mfma_f32_16x16x32_bf16 v[52:55], v[152:155], v[88:91], v[52:55]
    v_mfma_f32_16x16x32_bf16 v[56:59], v[152:155], v[100:103], v[56:59]
    v_mfma_f32_16x16x32_bf16 v[60:63], v[152:155], v[104:107], v[60:63]
    ds_read_b64 v[152:153], v40 offset:1856
    ds_read_b64 v[154:155], v40 offset:1864
    ds_read_b128 v[112:115], v45 offset:256
    ds_read_b128 v[116:119], v45 offset:768
    ds_read_b128 v[120:123], v45 offset:1280
    ds_read_b128 v[124:127], v45 offset:1792
    ds_read_b128 v[128:131], v45 offset:2304
    ds_read_b128 v[132:135], v45 offset:2816
    ds_read_b128 v[136:139], v45 offset:3328
    s_waitcnt lgkmcnt(13)
    v_mfma_f32_16x16x32_bf16 v[48:51], v[156:159], v[80:83], v[48:51]
    v_mfma_f32_16x16x32_bf16 v[52:55], v[156:159], v[84:87], v[52:55]
    v_mfma_f32_16x16x32_bf16 v[56:59], v[156:159], v[96:99], v[56:59]
    v_mfma_f32_16x16x32_bf16 v[60:63], v[156:159], v[100:103], v[60:63]
    ds_read_b64 v[156:157], v40 offset:1344
    ds_read_b64 v[158:159], v40 offset:1352
    s_waitcnt lgkmcnt(13)
    v_mfma_f32_16x16x32_bf16 v[52:55], v[144:147], v[80:83], v[52:55]
    v_mfma_f32_16x16x32_bf16 v[56:59], v[144:147], v[92:95], v[56:59]
    v_mfma_f32_16x16x32_bf16 v[60:63], v[144:147], v[96:99], v[60:63]
    ds_read_b64 v[144:145], v40 offset:832
    ds_read_b64 v[146:147], v40 offset:840
    s_waitcnt lgkmcnt(13)
    v_mfma_f32_16x16x32_bf16 v[56:59], v[148:151], v[88:91], v[56:59]
    v_mfma_f32_16x16x32_bf16 v[60:63], v[148:151], v[92:95], v[60:63]
    ds_read_b64 v[148:149], v40 offset:3840
    ds_read_b64 v[150:151], v40 offset:3848
    s_waitcnt lgkmcnt(13)
    v_mfma_f32_16x16x32_bf16 v[56:59], v[152:155], v[84:87], v[56:59]
    v_mfma_f32_16x16x32_bf16 v[60:63], v[152:155], v[88:91], v[60:63]
    ds_read_b64 v[152:153], v40 offset:3328
    ds_read_b64 v[154:155], v40 offset:3336
    s_waitcnt lgkmcnt(6)
    v_mfma_f32_16x16x32_bf16 v[56:59], v[156:159], v[80:83], v[56:59]
    v_mfma_f32_16x16x32_bf16 v[60:63], v[156:159], v[84:87], v[60:63]
    ds_read_b64 v[156:157], v40 offset:2816
    ds_read_b64 v[158:159], v40 offset:2824
    s_waitcnt lgkmcnt(6)
    v_mfma_f32_16x16x32_bf16 v[60:63], v[144:147], v[80:83], v[60:63]
    ds_read_b64 v[144:145], v40 offset:2304
    ds_read_b64 v[146:147], v40 offset:2312
    s_waitcnt lgkmcnt(6)
    v_mfma_f32_16x16x32_bf16 v[48:51], v[148:151], v[116:119], v[48:51]
    v_mfma_f32_16x16x32_bf16 v[52:55], v[148:151], v[120:123], v[52:55]
    v_mfma_f32_16x16x32_bf16 v[56:59], v[148:151], v[132:135], v[56:59]
    v_mfma_f32_16x16x32_bf16 v[60:63], v[148:151], v[136:139], v[60:63]
    ds_read_b64 v[148:149], v40 offset:1792
    ds_read_b64 v[150:151], v40 offset:1800
    ds_read_b128 v[80:83], v45 offset:192
    ds_read_b128 v[84:87], v45 offset:704
    ds_read_b128 v[88:91], v45 offset:1216
    ds_read_b128 v[92:95], v45 offset:1728
    ds_read_b128 v[96:99], v45 offset:2240
    ds_read_b128 v[100:103], v45 offset:2752
    ds_read_b128 v[104:107], v45 offset:3264
    s_waitcnt lgkmcnt(13)
    v_mfma_f32_16x16x32_bf16 v[48:51], v[152:155], v[112:115], v[48:51]
    v_mfma_f32_16x16x32_bf16 v[52:55], v[152:155], v[116:119], v[52:55]
    v_mfma_f32_16x16x32_bf16 v[56:59], v[152:155], v[128:131], v[56:59]
    v_mfma_f32_16x16x32_bf16 v[60:63], v[152:155], v[132:135], v[60:63]
    ds_read_b64 v[152:153], v40 offset:1280
    ds_read_b64 v[154:155], v40 offset:1288
    s_waitcnt lgkmcnt(13)
    v_mfma_f32_16x16x32_bf16 v[52:55], v[156:159], v[112:115], v[52:55]
    v_mfma_f32_16x16x32_bf16 v[56:59], v[156:159], v[124:127], v[56:59]
    v_mfma_f32_16x16x32_bf16 v[60:63], v[156:159], v[128:131], v[60:63]
    ds_read_b64 v[156:157], v40 offset:768
    ds_read_b64 v[158:159], v40 offset:776
    s_waitcnt lgkmcnt(13)
    v_mfma_f32_16x16x32_bf16 v[56:59], v[144:147], v[120:123], v[56:59]
    v_mfma_f32_16x16x32_bf16 v[60:63], v[144:147], v[124:127], v[60:63]
    ds_read_b64 v[144:145], v40 offset:3776
    ds_read_b64 v[146:147], v40 offset:3784
    s_waitcnt lgkmcnt(13)
    v_mfma_f32_16x16x32_bf16 v[56:59], v[148:151], v[116:119], v[56:59]
    v_mfma_f32_16x16x32_bf16 v[60:63], v[148:151], v[120:123], v[60:63]
    ds_read_b64 v[148:149], v40 offset:3264
    ds_read_b64 v[150:151], v40 offset:3272
    s_waitcnt lgkmcnt(6)
    v_mfma_f32_16x16x32_bf16 v[56:59], v[152:155], v[112:115], v[56:59]
    v_mfma_f32_16x16x32_bf16 v[60:63], v[152:155], v[116:119], v[60:63]
    ds_read_b64 v[152:153], v40 offset:2752
    ds_read_b64 v[154:155], v40 offset:2760
    s_waitcnt lgkmcnt(6)
    v_mfma_f32_16x16x32_bf16 v[60:63], v[156:159], v[112:115], v[60:63]
    ds_read_b64 v[156:157], v40 offset:2240
    ds_read_b64 v[158:159], v40 offset:2248
    s_waitcnt lgkmcnt(6)
    v_mfma_f32_16x16x32_bf16 v[48:51], v[144:147], v[84:87], v[48:51]
    v_mfma_f32_16x16x32_bf16 v[52:55], v[144:147], v[88:91], v[52:55]
    v_mfma_f32_16x16x32_bf16 v[56:59], v[144:147], v[100:103], v[56:59]
    v_mfma_f32_16x16x32_bf16 v[60:63], v[144:147], v[104:107], v[60:63]
    ds_read_b64 v[144:145], v40 offset:1728
    ds_read_b64 v[146:147], v40 offset:1736
    ds_read_b128 v[112:115], v45 offset:128
    ds_read_b128 v[116:119], v45 offset:640
    ds_read_b128 v[120:123], v45 offset:1152
    ds_read_b128 v[124:127], v45 offset:1664
    ds_read_b128 v[128:131], v45 offset:2176
    ds_read_b128 v[132:135], v45 offset:2688
    ds_read_b128 v[136:139], v45 offset:3200
    s_waitcnt lgkmcnt(13)
    v_mfma_f32_16x16x32_bf16 v[48:51], v[148:151], v[80:83], v[48:51]
    v_mfma_f32_16x16x32_bf16 v[52:55], v[148:151], v[84:87], v[52:55]
    v_mfma_f32_16x16x32_bf16 v[56:59], v[148:151], v[96:99], v[56:59]
    v_mfma_f32_16x16x32_bf16 v[60:63], v[148:151], v[100:103], v[60:63]
    ds_read_b64 v[148:149], v40 offset:1216
    ds_read_b64 v[150:151], v40 offset:1224
    s_waitcnt lgkmcnt(13)
    v_mfma_f32_16x16x32_bf16 v[52:55], v[152:155], v[80:83], v[52:55]
    v_mfma_f32_16x16x32_bf16 v[56:59], v[152:155], v[92:95], v[56:59]
    v_mfma_f32_16x16x32_bf16 v[60:63], v[152:155], v[96:99], v[60:63]
    ds_read_b64 v[152:153], v40 offset:704
    ds_read_b64 v[154:155], v40 offset:712
    s_waitcnt lgkmcnt(13)
    v_mfma_f32_16x16x32_bf16 v[56:59], v[156:159], v[88:91], v[56:59]
    v_mfma_f32_16x16x32_bf16 v[60:63], v[156:159], v[92:95], v[60:63]
    ds_read_b64 v[156:157], v40 offset:3712
    ds_read_b64 v[158:159], v40 offset:3720
    s_waitcnt lgkmcnt(13)
    v_mfma_f32_16x16x32_bf16 v[56:59], v[144:147], v[84:87], v[56:59]
    v_mfma_f32_16x16x32_bf16 v[60:63], v[144:147], v[88:91], v[60:63]
    ds_read_b64 v[144:145], v40 offset:3200
    ds_read_b64 v[146:147], v40 offset:3208
    s_waitcnt lgkmcnt(6)
    v_mfma_f32_16x16x32_bf16 v[56:59], v[148:151], v[80:83], v[56:59]
    v_mfma_f32_16x16x32_bf16 v[60:63], v[148:151], v[84:87], v[60:63]
    ds_read_b64 v[148:149], v40 offset:2688
    ds_read_b64 v[150:151], v40 offset:2696
    s_waitcnt lgkmcnt(6)
    v_mfma_f32_16x16x32_bf16 v[60:63], v[152:155], v[80:83], v[60:63]
    ds_read_b64 v[152:153], v40 offset:2176
    ds_read_b64 v[154:155], v40 offset:2184
    s_waitcnt lgkmcnt(6)
    v_mfma_f32_16x16x32_bf16 v[48:51], v[156:159], v[116:119], v[48:51]
    v_mfma_f32_16x16x32_bf16 v[52:55], v[156:159], v[120:123], v[52:55]
    v_mfma_f32_16x16x32_bf16 v[56:59], v[156:159], v[132:135], v[56:59]
    v_mfma_f32_16x16x32_bf16 v[60:63], v[156:159], v[136:139], v[60:63]
    ds_read_b64 v[156:157], v40 offset:1664
    ds_read_b64 v[158:159], v40 offset:1672
    ds_read_b128 v[80:83], v45 offset:64
    ds_read_b128 v[84:87], v45 offset:576
    ds_read_b128 v[88:91], v45 offset:1088
    ds_read_b128 v[92:95], v45 offset:1600
    ds_read_b128 v[96:99], v45 offset:2112
    ds_read_b128 v[100:103], v45 offset:2624
    ds_read_b128 v[104:107], v45 offset:3136
    s_waitcnt lgkmcnt(13)
    v_mfma_f32_16x16x32_bf16 v[48:51], v[144:147], v[112:115], v[48:51]
    v_mfma_f32_16x16x32_bf16 v[52:55], v[144:147], v[116:119], v[52:55]
    v_mfma_f32_16x16x32_bf16 v[56:59], v[144:147], v[128:131], v[56:59]
    v_mfma_f32_16x16x32_bf16 v[60:63], v[144:147], v[132:135], v[60:63]
    ds_read_b64 v[144:145], v40 offset:1152
    ds_read_b64 v[146:147], v40 offset:1160
    s_waitcnt lgkmcnt(13)
    v_mfma_f32_16x16x32_bf16 v[52:55], v[148:151], v[112:115], v[52:55]
    v_mfma_f32_16x16x32_bf16 v[56:59], v[148:151], v[124:127], v[56:59]
    v_mfma_f32_16x16x32_bf16 v[60:63], v[148:151], v[128:131], v[60:63]
    ds_read_b64 v[148:149], v40 offset:640
    ds_read_b64 v[150:151], v40 offset:648
    s_waitcnt lgkmcnt(13)
    v_mfma_f32_16x16x32_bf16 v[56:59], v[152:155], v[120:123], v[56:59]
    v_mfma_f32_16x16x32_bf16 v[60:63], v[152:155], v[124:127], v[60:63]
    ds_read_b64 v[152:153], v40 offset:3648
    ds_read_b64 v[154:155], v40 offset:3656
    s_waitcnt lgkmcnt(13)
    v_mfma_f32_16x16x32_bf16 v[56:59], v[156:159], v[116:119], v[56:59]
    v_mfma_f32_16x16x32_bf16 v[60:63], v[156:159], v[120:123], v[60:63]
    ds_read_b64 v[156:157], v40 offset:3136
    ds_read_b64 v[158:159], v40 offset:3144
    s_waitcnt lgkmcnt(6)
    v_mfma_f32_16x16x32_bf16 v[56:59], v[144:147], v[112:115], v[56:59]
    v_mfma_f32_16x16x32_bf16 v[60:63], v[144:147], v[116:119], v[60:63]
    ds_read_b64 v[144:145], v40 offset:2624
    ds_read_b64 v[146:147], v40 offset:2632
    s_waitcnt lgkmcnt(6)
    v_mfma_f32_16x16x32_bf16 v[60:63], v[148:151], v[112:115], v[60:63]
    ds_read_b64 v[148:149], v40 offset:2112
    ds_read_b64 v[150:151], v40 offset:2120
    s_waitcnt lgkmcnt(6)
    v_mfma_f32_16x16x32_bf16 v[48:51], v[152:155], v[84:87], v[48:51]
    v_mfma_f32_16x16x32_bf16 v[52:55], v[152:155], v[88:91], v[52:55]
    v_mfma_f32_16x16x32_bf16 v[56:59], v[152:155], v[100:103], v[56:59]
    v_mfma_f32_16x16x32_bf16 v[60:63], v[152:155], v[104:107], v[60:63]
    ds_read_b64 v[152:153], v40 offset:1600
    ds_read_b64 v[154:155], v40 offset:1608
    ds_read_b128 v[112:115], v45 offset:0
    ds_read_b128 v[116:119], v45 offset:512
    ds_read_b128 v[120:123], v45 offset:1024
    ds_read_b128 v[124:127], v45 offset:1536
    ds_read_b128 v[128:131], v45 offset:2048
    ds_read_b128 v[132:135], v45 offset:2560
    ds_read_b128 v[136:139], v45 offset:3072
    s_waitcnt lgkmcnt(13)
    v_mfma_f32_16x16x32_bf16 v[48:51], v[156:159], v[80:83], v[48:51]
    v_mfma_f32_16x16x32_bf16 v[52:55], v[156:159], v[84:87], v[52:55]
    v_mfma_f32_16x16x32_bf16 v[56:59], v[156:159], v[96:99], v[56:59]
    v_mfma_f32_16x16x32_bf16 v[60:63], v[156:159], v[100:103], v[60:63]
    ds_read_b64 v[156:157], v40 offset:1088
    ds_read_b64 v[158:159], v40 offset:1096
    s_waitcnt lgkmcnt(13)
    v_mfma_f32_16x16x32_bf16 v[52:55], v[144:147], v[80:83], v[52:55]
    v_mfma_f32_16x16x32_bf16 v[56:59], v[144:147], v[92:95], v[56:59]
    v_mfma_f32_16x16x32_bf16 v[60:63], v[144:147], v[96:99], v[60:63]
    ds_read_b64 v[144:145], v40 offset:576
    ds_read_b64 v[146:147], v40 offset:584
    s_waitcnt lgkmcnt(13)
    v_mfma_f32_16x16x32_bf16 v[56:59], v[148:151], v[88:91], v[56:59]
    v_mfma_f32_16x16x32_bf16 v[60:63], v[148:151], v[92:95], v[60:63]
    ds_read_b64 v[148:149], v40 offset:3584
    ds_read_b64 v[150:151], v40 offset:3592
    s_waitcnt lgkmcnt(13)
    v_mfma_f32_16x16x32_bf16 v[56:59], v[152:155], v[84:87], v[56:59]
    v_mfma_f32_16x16x32_bf16 v[60:63], v[152:155], v[88:91], v[60:63]
    ds_read_b64 v[152:153], v40 offset:3072
    ds_read_b64 v[154:155], v40 offset:3080
    s_waitcnt lgkmcnt(6)
    v_mfma_f32_16x16x32_bf16 v[56:59], v[156:159], v[80:83], v[56:59]
    v_mfma_f32_16x16x32_bf16 v[60:63], v[156:159], v[84:87], v[60:63]
    ds_read_b64 v[156:157], v40 offset:2560
    ds_read_b64 v[158:159], v40 offset:2568
    s_waitcnt lgkmcnt(6)
    v_mfma_f32_16x16x32_bf16 v[60:63], v[144:147], v[80:83], v[60:63]
    ds_read_b64 v[144:145], v40 offset:2048
    ds_read_b64 v[146:147], v40 offset:2056
    s_waitcnt lgkmcnt(6)
    v_mfma_f32_16x16x32_bf16 v[48:51], v[148:151], v[116:119], v[48:51]
    v_mfma_f32_16x16x32_bf16 v[52:55], v[148:151], v[120:123], v[52:55]
    v_mfma_f32_16x16x32_bf16 v[56:59], v[148:151], v[132:135], v[56:59]
    v_mfma_f32_16x16x32_bf16 v[60:63], v[148:151], v[136:139], v[60:63]
    ds_read_b64 v[148:149], v40 offset:1536
    ds_read_b64 v[150:151], v40 offset:1544
    s_waitcnt lgkmcnt(6)
    v_mfma_f32_16x16x32_bf16 v[48:51], v[152:155], v[112:115], v[48:51]
    v_mfma_f32_16x16x32_bf16 v[52:55], v[152:155], v[116:119], v[52:55]
    v_mfma_f32_16x16x32_bf16 v[56:59], v[152:155], v[128:131], v[56:59]
    v_mfma_f32_16x16x32_bf16 v[60:63], v[152:155], v[132:135], v[60:63]
    ds_read_b64 v[152:153], v40 offset:1024
    ds_read_b64 v[154:155], v40 offset:1032
    s_waitcnt lgkmcnt(6)
    v_mfma_f32_16x16x32_bf16 v[52:55], v[156:159], v[112:115], v[52:55]
    v_mfma_f32_16x16x32_bf16 v[56:59], v[156:159], v[124:127], v[56:59]
    v_mfma_f32_16x16x32_bf16 v[60:63], v[156:159], v[128:131], v[60:63]
    ds_read_b64 v[156:157], v40 offset:512
    ds_read_b64 v[158:159], v40 offset:520
    s_waitcnt lgkmcnt(6)
    v_mfma_f32_16x16x32_bf16 v[56:59], v[144:147], v[120:123], v[56:59]
    v_mfma_f32_16x16x32_bf16 v[60:63], v[144:147], v[124:127], v[60:63]
    s_waitcnt lgkmcnt(4)
    v_mfma_f32_16x16x32_bf16 v[56:59], v[148:151], v[116:119], v[56:59]
    v_mfma_f32_16x16x32_bf16 v[60:63], v[148:151], v[120:123], v[60:63]
    s_waitcnt lgkmcnt(2)
    v_mfma_f32_16x16x32_bf16 v[56:59], v[152:155], v[112:115], v[56:59]
    v_mfma_f32_16x16x32_bf16 v[60:63], v[152:155], v[116:119], v[60:63]
    s_waitcnt lgkmcnt(0)
    v_mfma_f32_16x16x32_bf16 v[60:63], v[156:159], v[112:115], v[60:63]
    v_cvt_pk_bf16_f32 v192, v48, v49
    v_cvt_pk_bf16_f32 v193, v50, v51
    v_lshlrev_b32 v48, 16, v192
    v_and_b32 v49, 0xffff0000, v192
    v_lshlrev_b32 v50, 16, v193
    v_and_b32 v51, 0xffff0000, v193
    v_pk_add_f32 v[48:49], v[48:49], v[168:169]
    v_pk_add_f32 v[50:51], v[50:51], v[170:171]
    v_cvt_pk_bf16_f32 v184, v48, v49
    v_cvt_pk_bf16_f32 v185, v50, v51
    buffer_store_dwordx2 v[184:185], v164, s[32:35], s76 offen offset:512 sc1
    v_cvt_pk_bf16_f32 v192, v52, v53
    v_cvt_pk_bf16_f32 v193, v54, v55
    v_lshlrev_b32 v52, 16, v192
    v_and_b32 v53, 0xffff0000, v192
    v_lshlrev_b32 v54, 16, v193
    v_and_b32 v55, 0xffff0000, v193
    v_pk_add_f32 v[52:53], v[52:53], v[172:173]
    v_pk_add_f32 v[54:55], v[54:55], v[174:175]
    v_cvt_pk_bf16_f32 v186, v52, v53
    v_cvt_pk_bf16_f32 v187, v54, v55
    buffer_store_dwordx2 v[186:187], v164, s[32:35], s76 offen offset:1024 sc1
    v_cvt_pk_bf16_f32 v192, v56, v57
    v_cvt_pk_bf16_f32 v193, v58, v59
    v_lshlrev_b32 v56, 16, v192
    v_and_b32 v57, 0xffff0000, v192
    v_lshlrev_b32 v58, 16, v193
    v_and_b32 v59, 0xffff0000, v193
    v_pk_add_f32 v[56:57], v[56:57], v[176:177]
    v_pk_add_f32 v[58:59], v[58:59], v[178:179]
    v_cvt_pk_bf16_f32 v188, v56, v57
    v_cvt_pk_bf16_f32 v189, v58, v59
    buffer_store_dwordx2 v[188:189], v164, s[32:35], s76 offen offset:2560 sc1
    v_cvt_pk_bf16_f32 v192, v60, v61
    v_cvt_pk_bf16_f32 v193, v62, v63
    v_lshlrev_b32 v60, 16, v192
    v_and_b32 v61, 0xffff0000, v192
    v_lshlrev_b32 v62, 16, v193
    v_and_b32 v63, 0xffff0000, v193
    v_pk_add_f32 v[60:61], v[60:61], v[180:181]
    v_pk_add_f32 v[62:63], v[62:63], v[182:183]
    v_cvt_pk_bf16_f32 v190, v60, v61
    v_cvt_pk_bf16_f32 v191, v62, v63
    buffer_store_dwordx2 v[190:191], v164, s[32:35], s76 offen offset:3072 sc1
SSM_CVX:
    s_waitcnt vmcnt(0)
    s_lshl_b32 s53, s50, 1
    s_add_u32 s53, s53, s70
    s_lshl_b32 s53, s53, 1
    s_add_u32 s53, s53, s71
    s_lshl_b32 s53, s53, 2
    s_add_u32 s53, s53, 8192
    v_mov_b32 v5, s49
    v_mov_b32 v6, 0
    s_mov_b64 exec, 1
    buffer_store_dword v5, v6, s[40:43], s53 offen sc1
    s_mov_b64 exec, -1
    s_endpgm
K_END:
    s_endpgm
.section .rodata,"a"
.p2align 6
.amdhsa_kernel parallel_sum__ssm_conv_s4d__glu_gated_glu__prompt_kernel
  .amdhsa_next_free_vgpr 256
  .amdhsa_next_free_sgpr 102
  .amdhsa_accum_offset 256
  .amdhsa_group_segment_fixed_size 0
  .amdhsa_kernarg_size 112
  .amdhsa_user_sgpr_count 2
  .amdhsa_user_sgpr_kernarg_segment_ptr 1
  .amdhsa_system_sgpr_workgroup_id_x 1
.end_amdhsa_kernel
.text
```
